```python
import torch

def _softmax(x, axis=-1):
    return torch.softmax(x, dim=axis)
def _gelu(x):
    return torch.nn.functional.gelu(x, approximate="tanh")
def _silu(x):
    return torch.nn.functional.silu(x)
def _sigmoid(x):
    return torch.sigmoid(x)
def _layernorm(x, axis=-1, eps=1e-5):
    m = x.mean(dim=axis, keepdim=True)
    v = x.var(dim=axis, keepdim=True, unbiased=False)
    return (x - m) / torch.sqrt(v + eps)
def _scatter_add(tgt, idx, src, axis=0):
    return tgt.clone().index_add_(axis, idx, src)
def _segment_sum(src, seg, n):
    out = torch.zeros((n,) + src.shape[1:], dtype=src.dtype)
    return out.index_add_(0, seg, src)
def _pad(x, pw):
    flat = tuple(v for pair in reversed(pw) for v in pair)
    return torch.nn.functional.pad(x, flat)

kernel_name = 'concat_heads__linear_kernel_hedgehog__mha_block__prompt'

def setup_inputs():

    _w = (lambda a: (lambda t: t.to(torch.bfloat16) if t.is_floating_point() else t)(torch.as_tensor(a)))
    def _A_setup():
        B, S, D, H = 1, 2048, 1024, 32
        Dh = D // H
        return {
            "x": _w((lambda *s: torch.randn(*s, dtype=torch.bfloat16) * 0.4)(B, S, D)),
            "wqkv": _w((lambda *s: torch.randn(*s, dtype=torch.bfloat16) * 0.4)(D, 3 * D)),
            "w_phi": _w((lambda *s: torch.randn(*s, dtype=torch.bfloat16) * 0.4)(H, Dh, Dh) * (Dh ** -0.5)),
            "wo": _w((lambda *s: torch.randn(*s, dtype=torch.bfloat16) * 0.05)(D, D)),
        }
    _A_in = _A_setup()

    def _B_setup():
        B, S, D, H = 1, 2048, 1024, 32
        return {
            "x": _w((lambda *s: torch.randn(*s, dtype=torch.bfloat16) * 0.2)(B, S, D)),
            "wqkv": _w((lambda *s: torch.randn(*s, dtype=torch.bfloat16) * 0.2)(D, 3 * D)),
            "wo": _w((lambda *s: torch.randn(*s, dtype=torch.bfloat16) * 0.05)(D, D)),
        }
    _B_in = _B_setup()

    return {
        "A_x": _A_in["x"],
        "A_wqkv": _A_in["wqkv"],
        "A_w_phi": _A_in["w_phi"],
        "A_wo": _A_in["wo"],
        "B_x": _B_in["x"],
        "B_wqkv": _B_in["wqkv"],
        "B_wo": _B_in["wo"],
    }

def reference(A_x, A_wqkv, A_w_phi, A_wo, B_x, B_wqkv, B_wo):
    def _A_ref(x, wqkv, w_phi, wo):
        B, S, D = x.shape
        H = 32; Dh = D // H
        qkv = (lambda x, *d: x.permute(*d))((x @ wqkv).reshape(B, S, 3, H, Dh), 2, 0, 3, 1, 4)
        q, k, v = qkv[0], qkv[1], qkv[2]
        pq = torch.einsum("bhsd,hdf->bhsf", q, w_phi)
        pk = torch.einsum("bhsd,hdf->bhsf", k, w_phi)
        phi_q = torch.concatenate([_softmax(pq, axis=-1), _softmax(-pq, axis=-1)], axis=-1)
        phi_k = torch.concatenate([_softmax(pk, axis=-1), _softmax(-pk, axis=-1)], axis=-1)
        kv = torch.einsum("bhsf,bhsd->bhfd", phi_k, v)
        z  = torch.einsum("bhsf->bhf", phi_k)
        num = torch.einsum("bhqf,bhfd->bhqd", phi_q, kv)
        den = torch.einsum("bhqf,bhf->bhq", phi_q, z)[..., None] + 1e-6
        o = num / den
        return (lambda x, *d: x.permute(*d))(o, 0, 2, 1, 3).reshape(B, S, D) @ wo

    def _B_ref(x, wqkv, wo):
        B, S, D = x.shape
        H = 32
        Dh = D // H
        qkv = (lambda x, *d: x.permute(*d))((x @ wqkv).reshape(B, S, 3, H, Dh), 2, 0, 3, 1, 4)
        q, k, v = qkv[0], qkv[1], qkv[2]
        scores = torch.einsum("bhqd,bhkd->bhqk", q, k) * (Dh ** -0.5)
        p = _softmax(scores, axis=-1)
        o = torch.einsum("bhqk,bhkd->bhqd", p, v)
        return (lambda x, *d: x.permute(*d))(o, 0, 2, 1, 3).reshape(B, S, D) @ wo

    a = _A_ref(A_x, A_wqkv, A_w_phi, A_wo)
    b = _B_ref(B_x, B_wqkv, B_wo)
    return torch.concatenate([a, b], axis=-1)
```

```asm
; @launch kernel=concat_heads__linear_kernel_hedgehog__mha_block__prompt_kernel grid=(256,1,1) block=(512,1,1) lds=163840
.amdgcn_target "amdgcn-amd-amdhsa--gfx950"
.text
.globl concat_heads__linear_kernel_hedgehog__mha_block__prompt_kernel
.p2align 8
.type concat_heads__linear_kernel_hedgehog__mha_block__prompt_kernel,@function
concat_heads__linear_kernel_hedgehog__mha_block__prompt_kernel:

    s_getpc_b64 s[94:95]
L_pc:
    s_cmp_ge_u32 s2, 256
    s_cbranch_scc1 L_end
    s_and_b32 s3, s2, 7
    s_bfe_u32 s24, s2, 65539
    s_lshl_b32 s29, s24, 5
    s_load_dwordx4 s[4:7], s[0:1], s29
    s_load_dwordx2 s[32:33], s[0:1], 72
    s_load_dwordx2 s[34:35], s[0:1], 16
    s_mov_b32 s99, s24
    s_mul_i32 s29, s99, 24
    s_add_u32 s29, s29, 24
    s_load_dwordx2 s[52:53], s[0:1], s29
    s_load_dwordx4 s[44:47], s[0:1], 56
    s_and_b32 s25, s3, 1
    s_lshl_b32 s25, s25, 2
    s_bfe_u32 s29, s2, 131076
    s_add_u32 s25, s25, s29
    s_bfe_u32 s26, s3, 131073
    s_lshl_b32 s26, s26, 2
    s_lshr_b32 s29, s2, 6
    s_add_u32 s26, s26, s29
    v_lshrrev_b32 v1, 6, v0
    v_and_b32 v0, 63, v0
    v_readfirstlane_b32 s27, v1
    s_lshl_b32 s29, s25, 19
    s_mov_b32 s10, 0x80000
    s_mov_b32 s11, 0x20000
    s_mov_b32 s14, 0x600000
    s_mov_b32 s15, 0x20000
    s_mov_b32 s18, 0x10000000
    s_mov_b32 s19, 0x20000
    s_mov_b32 s22, 0x10000
    s_mov_b32 s23, 0x20000
    s_mov_b32 s54, 0x200000
    s_mov_b32 s55, 0x20000
    s_mov_b32 s58, 0x800000
    s_mov_b32 s59, 0x20000
    s_mov_b32 s86, 256
    s_mov_b32 s87, 0x20000
    s_waitcnt lgkmcnt(0)
    s_add_u32 s8, s4, s29
    s_addc_u32 s9, s5, 0
    s_mov_b32 s12, s6
    s_mov_b32 s13, s7
    s_mov_b32 s16, s32
    s_mov_b32 s17, s33
    s_mov_b32 s20, s34
    s_mov_b32 s21, s35
    s_mov_b32 s56, s44
    s_mov_b32 s57, s45
    s_mov_b32 s84, s46
    s_mov_b32 s85, s47
    s_cmp_lt_u32 s27, 4
    s_cbranch_scc1 L_compute
    s_mov_b32 s49, 0
    s_sub_u32 s36, s27, 4
    v_lshrrev_b32 v1, 3, v0
    v_and_b32 v2, 7, v0
    v_lshrrev_b32 v3, 1, v1
    s_lshl_b32 s29, s36, 3
    v_add_u32 v5, s29, v1
    v_and_b32 v6, 1, v3
    s_and_b32 s29, s36, 1
    s_lshl_b32 s29, s29, 2
    v_lshl_add_u32 v6, v6, 1, s29
    v_xor_b32 v6, v6, v2
    v_lshlrev_b32 v6, 4, v6
    v_mul_u32_u24 v16, 6144, v5
    s_lshl_b32 s29, s26, 7
    v_add3_u32 v16, v16, v6, s29
    v_add_u32 v17, 2048, v16
    v_add_u32 v18, 4096, v16
    s_lshl_b32 s37, s36, 10
    s_add_u32 s30, s37, 61440
    s_mov_b32 s31, s37
    s_lshl_b32 s38, s49, 7
    s_mul_i32 s39, s49, 393216
    s_add_u32 s40, s37, 159744
    s_add_u32 s41, s37, 61440
    s_add_u32 s42, s37, 61440
    s_add_u32 s32, s25, s26
    s_lshl_b32 s34, s24, 1
    s_lshl_b32 s35, s34, 1
    s_and_b32 s32, s32, 3
    s_mov_b32 s96, 1985229328
    s_mov_b32 s97, 4275878552
    s_mov_b32 s34, 0
    s_mov_b32 s35, 0
    s_cmp_eq_u32 s32, 1
    s_cselect_b32 s96, 1732584193, s96
    s_cselect_b32 s97, 4023233417, s97
    s_cmp_eq_u32 s32, 2
    s_cselect_b32 s96, 1985229328, s96
    s_cselect_b32 s97, 4275878552, s97
    s_cmp_eq_u32 s32, 3
    s_cselect_b32 s96, 1732584193, s96
    s_cselect_b32 s97, 4023233417, s97
    s_mul_i32 s29, s49, 0x11111111
    s_xor_b32 s97, s97, s29
    s_xor_b32 s96, s96, s29
    s_lshr_b32 s33, s35, 1
    s_lshl_b32 s29, s33, 2
    s_lshr_b64 s[88:89], s[96:97], s29
    s_and_b32 s39, s88, 15
    s_lshl_b32 s39, s39, 1
    s_and_b32 s29, s35, 1
    s_add_u32 s39, s39, s29
    s_mul_i32 s39, s39, 196608
    s_add_u32 s35, s35, 1
    s_add_u32 m0, s31, 0
    s_nop 0
    buffer_load_dwordx4 v16, s[12:15], s39 offen lds
    s_add_u32 m0, s31, 4096
    s_nop 0
    buffer_load_dwordx4 v17, s[12:15], s39 offen lds
    s_add_u32 m0, s31, 8192
    s_nop 0
    buffer_load_dwordx4 v18, s[12:15], s39 offen lds
    s_add_u32 s31, s31, 12288
    s_cmp_eq_u32 s31, s41
    s_cselect_b32 s31, s37, s31
    s_and_b32 s29, s36, 1
    s_lshl_b32 s29, s29, 2
    v_add_u32 v4, s29, v3
    v_xor_b32 v4, v4, v2
    v_lshlrev_b32 v4, 4, v4
    v_lshl_add_u32 v8, v5, 11, v4
    v_add_u32 v9, 65536, v8
    v_add_u32 v10, 131072, v8
    v_add_u32 v11, 196608, v8
    v_add_u32 v12, 262144, v8
    v_add_u32 v13, 327680, v8
    v_add_u32 v14, 393216, v8
    v_add_u32 v15, 458752, v8
    s_lshl_b32 s29, s34, 2
    s_lshr_b64 s[88:89], s[96:97], s29
    s_and_b32 s38, s88, 15
    s_lshl_b32 s38, s38, 7
    s_add_u32 s34, s34, 1
    s_add_u32 m0, s30, 0
    s_nop 0
    buffer_load_dwordx4 v8, s[8:11], s38 offen lds
    s_add_u32 m0, s30, 4096
    s_nop 0
    buffer_load_dwordx4 v9, s[8:11], s38 offen lds
    s_add_u32 m0, s30, 8192
    s_nop 0
    buffer_load_dwordx4 v10, s[8:11], s38 offen lds
    s_add_u32 m0, s30, 12288
    s_nop 0
    buffer_load_dwordx4 v11, s[8:11], s38 offen lds
    s_add_u32 m0, s30, 16384
    s_nop 0
    buffer_load_dwordx4 v12, s[8:11], s38 offen lds
    s_add_u32 m0, s30, 20480
    s_nop 0
    buffer_load_dwordx4 v13, s[8:11], s38 offen lds
    s_add_u32 m0, s30, 24576
    s_nop 0
    buffer_load_dwordx4 v14, s[8:11], s38 offen lds
    s_add_u32 m0, s30, 28672
    s_nop 0
    buffer_load_dwordx4 v15, s[8:11], s38 offen lds
    s_add_u32 s30, s30, 32768
    s_cmp_eq_u32 s30, s40
    s_cselect_b32 s30, s42, s30
    s_lshr_b32 s33, s35, 1
    s_lshl_b32 s29, s33, 2
    s_lshr_b64 s[88:89], s[96:97], s29
    s_and_b32 s39, s88, 15
    s_lshl_b32 s39, s39, 1
    s_and_b32 s29, s35, 1
    s_add_u32 s39, s39, s29
    s_mul_i32 s39, s39, 196608
    s_add_u32 s35, s35, 1
    s_add_u32 m0, s31, 0
    s_nop 0
    buffer_load_dwordx4 v16, s[12:15], s39 offen lds
    s_add_u32 m0, s31, 4096
    s_nop 0
    buffer_load_dwordx4 v17, s[12:15], s39 offen lds
    s_add_u32 m0, s31, 8192
    s_nop 0
    buffer_load_dwordx4 v18, s[12:15], s39 offen lds
    s_add_u32 s31, s31, 12288
    s_cmp_eq_u32 s31, s41
    s_cselect_b32 s31, s37, s31
    v_lshlrev_b32 v19, 4, v0
    s_mov_b32 s92, 0
    s_waitcnt vmcnt(3)
    s_barrier
    s_lshl_b32 s29, s36, 9
    s_add_u32 s29, s29, 159744
    v_lshl_add_u32 v20, v0, 3, s29
    ds_read_b64 v[250:251], v20
    s_lshl_b32 s29, s34, 2
    s_lshr_b64 s[88:89], s[96:97], s29
    s_and_b32 s38, s88, 15
    s_lshl_b32 s38, s38, 7
    s_add_u32 s34, s34, 1
    s_add_u32 m0, s30, 0
    s_nop 0
    buffer_load_dwordx4 v8, s[8:11], s38 offen lds
    s_add_u32 m0, s30, 4096
    s_nop 0
    buffer_load_dwordx4 v9, s[8:11], s38 offen lds
    s_add_u32 m0, s30, 8192
    s_nop 0
    buffer_load_dwordx4 v10, s[8:11], s38 offen lds
    s_add_u32 m0, s30, 12288
    s_nop 0
    buffer_load_dwordx4 v11, s[8:11], s38 offen lds
    s_add_u32 m0, s30, 16384
    s_nop 0
    buffer_load_dwordx4 v12, s[8:11], s38 offen lds
    s_add_u32 m0, s30, 20480
    s_nop 0
    buffer_load_dwordx4 v13, s[8:11], s38 offen lds
    s_add_u32 m0, s30, 24576
    s_nop 0
    buffer_load_dwordx4 v14, s[8:11], s38 offen lds
    s_add_u32 m0, s30, 28672
    s_nop 0
    buffer_load_dwordx4 v15, s[8:11], s38 offen lds
    s_add_u32 s30, s30, 32768
    s_cmp_eq_u32 s30, s40
    s_cselect_b32 s30, s42, s30
    s_lshr_b32 s33, s35, 1
    s_lshl_b32 s29, s33, 2
    s_lshr_b64 s[88:89], s[96:97], s29
    s_and_b32 s39, s88, 15
    s_lshl_b32 s39, s39, 1
    s_and_b32 s29, s35, 1
    s_add_u32 s39, s39, s29
    s_mul_i32 s39, s39, 196608
    s_add_u32 s35, s35, 1
    s_add_u32 m0, s31, 0
    s_nop 0
    buffer_load_dwordx4 v16, s[12:15], s39 offen lds
    s_add_u32 m0, s31, 4096
    s_nop 0
    buffer_load_dwordx4 v17, s[12:15], s39 offen lds
    s_add_u32 m0, s31, 8192
    s_nop 0
    buffer_load_dwordx4 v18, s[12:15], s39 offen lds
    s_add_u32 s31, s31, 12288
    s_cmp_eq_u32 s31, s41
    s_cselect_b32 s31, s37, s31
    s_waitcnt vmcnt(11)
    s_barrier
    s_lshr_b32 s33, s35, 1
    s_lshl_b32 s29, s33, 2
    s_lshr_b64 s[88:89], s[96:97], s29
    s_and_b32 s39, s88, 15
    s_lshl_b32 s39, s39, 1
    s_and_b32 s29, s35, 1
    s_add_u32 s39, s39, s29
    s_mul_i32 s39, s39, 196608
    s_add_u32 s35, s35, 1
    s_add_u32 m0, s31, 0
    s_nop 0
    buffer_load_dwordx4 v16, s[12:15], s39 offen lds
    s_add_u32 m0, s31, 4096
    s_nop 0
    buffer_load_dwordx4 v17, s[12:15], s39 offen lds
    s_add_u32 m0, s31, 8192
    s_nop 0
    buffer_load_dwordx4 v18, s[12:15], s39 offen lds
    s_add_u32 s31, s31, 12288
    s_cmp_eq_u32 s31, s41
    s_cselect_b32 s31, s37, s31
    s_lshl_b32 s29, s34, 2
    s_lshr_b64 s[88:89], s[96:97], s29
    s_and_b32 s38, s88, 15
    s_lshl_b32 s38, s38, 7
    s_add_u32 s34, s34, 1
    s_add_u32 m0, s30, 0
    s_nop 0
    buffer_load_dwordx4 v8, s[8:11], s38 offen lds
    s_add_u32 m0, s30, 4096
    s_nop 0
    buffer_load_dwordx4 v9, s[8:11], s38 offen lds
    s_add_u32 m0, s30, 8192
    s_nop 0
    buffer_load_dwordx4 v10, s[8:11], s38 offen lds
    s_add_u32 m0, s30, 12288
    s_nop 0
    buffer_load_dwordx4 v11, s[8:11], s38 offen lds
    s_add_u32 m0, s30, 16384
    s_nop 0
    buffer_load_dwordx4 v12, s[8:11], s38 offen lds
    s_add_u32 m0, s30, 20480
    s_nop 0
    buffer_load_dwordx4 v13, s[8:11], s38 offen lds
    s_add_u32 m0, s30, 24576
    s_nop 0
    buffer_load_dwordx4 v14, s[8:11], s38 offen lds
    s_add_u32 m0, s30, 28672
    s_nop 0
    buffer_load_dwordx4 v15, s[8:11], s38 offen lds
    s_add_u32 s30, s30, 32768
    s_cmp_eq_u32 s30, s40
    s_cselect_b32 s30, s42, s30
    s_waitcnt vmcnt(11)
    s_barrier
    s_waitcnt lgkmcnt(0)
    s_lshr_b32 s33, s35, 1
    s_lshl_b32 s29, s33, 2
    s_lshr_b64 s[88:89], s[96:97], s29
    s_and_b32 s39, s88, 15
    s_lshl_b32 s39, s39, 1
    s_and_b32 s29, s35, 1
    s_add_u32 s39, s39, s29
    s_mul_i32 s39, s39, 196608
    s_add_u32 s35, s35, 1
    s_add_u32 m0, s31, 0
    s_nop 0
    buffer_load_dwordx4 v16, s[12:15], s39 offen lds
    s_add_u32 m0, s31, 4096
    s_nop 0
    buffer_load_dwordx4 v17, s[12:15], s39 offen lds
    s_add_u32 m0, s31, 8192
    s_nop 0
    buffer_load_dwordx4 v18, s[12:15], s39 offen lds
    s_add_u32 s31, s31, 12288
    s_cmp_eq_u32 s31, s41
    s_cselect_b32 s31, s37, s31
    s_lshr_b32 s33, s35, 1
    s_lshl_b32 s29, s33, 2
    s_lshr_b64 s[88:89], s[96:97], s29
    s_and_b32 s39, s88, 15
    s_lshl_b32 s39, s39, 1
    s_and_b32 s29, s35, 1
    s_add_u32 s39, s39, s29
    s_mul_i32 s39, s39, 196608
    s_add_u32 s35, s35, 1
    s_add_u32 m0, s31, 0
    s_nop 0
    buffer_load_dwordx4 v16, s[12:15], s39 offen lds
    s_add_u32 m0, s31, 4096
    s_nop 0
    buffer_load_dwordx4 v17, s[12:15], s39 offen lds
    s_add_u32 m0, s31, 8192
    s_nop 0
    buffer_load_dwordx4 v18, s[12:15], s39 offen lds
    s_add_u32 s31, s31, 12288
    s_cmp_eq_u32 s31, s41
    s_cselect_b32 s31, s37, s31
    s_lshr_b32 s33, s35, 1
    s_lshl_b32 s29, s33, 2
    s_lshr_b64 s[88:89], s[96:97], s29
    s_and_b32 s39, s88, 15
    s_lshl_b32 s39, s39, 1
    s_and_b32 s29, s35, 1
    s_add_u32 s39, s39, s29
    s_mul_i32 s39, s39, 196608
    s_add_u32 s35, s35, 1
    s_add_u32 m0, s31, 0
    s_nop 0
    buffer_load_dwordx4 v16, s[12:15], s39 offen lds
    s_add_u32 m0, s31, 4096
    s_nop 0
    buffer_load_dwordx4 v17, s[12:15], s39 offen lds
    s_add_u32 m0, s31, 8192
    s_nop 0
    buffer_load_dwordx4 v18, s[12:15], s39 offen lds
    s_add_u32 s31, s31, 12288
    s_cmp_eq_u32 s31, s41
    s_cselect_b32 s31, s37, s31
    s_mov_b32 s28, 12
    v_mov_b32 v31, 0
    v_mov_b32 v30, 0x100
L_p1_lloop:
    s_waitcnt vmcnt(17)
    s_barrier
    s_lshl_b32 s29, s34, 2
    s_lshr_b64 s[88:89], s[96:97], s29
    s_and_b32 s38, s88, 15
    s_lshl_b32 s38, s38, 7
    s_add_u32 s34, s34, 1
    s_add_u32 m0, s30, 0
    s_nop 0
    buffer_load_dwordx4 v8, s[8:11], s38 offen lds
    s_add_u32 m0, s30, 4096
    s_nop 0
    buffer_load_dwordx4 v9, s[8:11], s38 offen lds
    s_add_u32 m0, s30, 8192
    s_nop 0
    buffer_load_dwordx4 v10, s[8:11], s38 offen lds
    s_add_u32 m0, s30, 12288
    s_nop 0
    buffer_load_dwordx4 v11, s[8:11], s38 offen lds
    s_add_u32 m0, s30, 16384
    s_nop 0
    buffer_load_dwordx4 v12, s[8:11], s38 offen lds
    s_add_u32 m0, s30, 20480
    s_nop 0
    buffer_load_dwordx4 v13, s[8:11], s38 offen lds
    s_add_u32 m0, s30, 24576
    s_nop 0
    buffer_load_dwordx4 v14, s[8:11], s38 offen lds
    s_add_u32 m0, s30, 28672
    s_nop 0
    buffer_load_dwordx4 v15, s[8:11], s38 offen lds
    s_add_u32 s30, s30, 32768
    s_cmp_eq_u32 s30, s40
    s_cselect_b32 s30, s42, s30
    s_lshr_b32 s33, s35, 1
    s_lshl_b32 s29, s33, 2
    s_lshr_b64 s[88:89], s[96:97], s29
    s_and_b32 s39, s88, 15
    s_lshl_b32 s39, s39, 1
    s_and_b32 s29, s35, 1
    s_add_u32 s39, s39, s29
    s_mul_i32 s39, s39, 196608
    s_add_u32 s35, s35, 1
    s_add_u32 m0, s31, 0
    s_nop 0
    buffer_load_dwordx4 v16, s[12:15], s39 offen lds
    s_add_u32 m0, s31, 4096
    s_nop 0
    buffer_load_dwordx4 v17, s[12:15], s39 offen lds
    s_add_u32 m0, s31, 8192
    s_nop 0
    buffer_load_dwordx4 v18, s[12:15], s39 offen lds
    s_add_u32 s31, s31, 12288
    s_cmp_eq_u32 s31, s41
    s_cselect_b32 s31, s37, s31
    s_waitcnt vmcnt(17)
    s_barrier
    s_lshr_b32 s33, s35, 1
    s_lshl_b32 s29, s33, 2
    s_lshr_b64 s[88:89], s[96:97], s29
    s_and_b32 s39, s88, 15
    s_lshl_b32 s39, s39, 1
    s_and_b32 s29, s35, 1
    s_add_u32 s39, s39, s29
    s_mul_i32 s39, s39, 196608
    s_add_u32 s35, s35, 1
    s_add_u32 m0, s31, 0
    s_nop 0
    buffer_load_dwordx4 v16, s[12:15], s39 offen lds
    s_add_u32 m0, s31, 4096
    s_nop 0
    buffer_load_dwordx4 v17, s[12:15], s39 offen lds
    s_add_u32 m0, s31, 8192
    s_nop 0
    buffer_load_dwordx4 v18, s[12:15], s39 offen lds
    s_add_u32 s31, s31, 12288
    s_cmp_eq_u32 s31, s41
    s_cselect_b32 s31, s37, s31
    s_bfe_u32 s29, s2, 131075
    s_add_u32 s29, s29, 8
    s_cmp_lg_u32 s28, s29
    s_cbranch_scc1 L_snap3
    s_cmp_lg_u32 s27, 4
    s_cbranch_scc1 L_w4_1
    v_mov_b32 v20, 1
    v_mov_b32 v21, 0
    s_mov_b64 exec, 1
    buffer_atomic_add v20, v21, s[84:87], 0 offen sc1
    s_mov_b64 exec, -1
L_w4_1:
L_snap3:
    s_bfe_u32 s29, s2, 0x20003
    s_add_u32 s29, s29, 1
    s_cmp_lg_u32 s28, s29
    s_cbranch_scc1 L_snap4
    s_cmp_lg_u32 s27, 4
    s_cbranch_scc1 L_snap4
    buffer_load_dword v30, v31, s[84:87], 0 offen sc0 sc1
L_snap4:
    s_sub_u32 s28, s28, 1
    s_cmp_lg_u32 s28, 0
    s_cbranch_scc1 L_p1_lloop
    s_waitcnt vmcnt(17)
    s_barrier
    s_lshl_b32 s29, s34, 2
    s_lshr_b64 s[88:89], s[96:97], s29
    s_and_b32 s38, s88, 15
    s_lshl_b32 s38, s38, 7
    s_add_u32 s34, s34, 1
    s_add_u32 m0, s30, 0
    s_nop 0
    buffer_load_dwordx4 v8, s[8:11], s38 offen lds
    s_add_u32 m0, s30, 4096
    s_nop 0
    buffer_load_dwordx4 v9, s[8:11], s38 offen lds
    s_add_u32 m0, s30, 8192
    s_nop 0
    buffer_load_dwordx4 v10, s[8:11], s38 offen lds
    s_add_u32 m0, s30, 12288
    s_nop 0
    buffer_load_dwordx4 v11, s[8:11], s38 offen lds
    s_add_u32 m0, s30, 16384
    s_nop 0
    buffer_load_dwordx4 v12, s[8:11], s38 offen lds
    s_add_u32 m0, s30, 20480
    s_nop 0
    buffer_load_dwordx4 v13, s[8:11], s38 offen lds
    s_add_u32 m0, s30, 24576
    s_nop 0
    buffer_load_dwordx4 v14, s[8:11], s38 offen lds
    s_add_u32 m0, s30, 28672
    s_nop 0
    buffer_load_dwordx4 v15, s[8:11], s38 offen lds
    s_add_u32 s30, s30, 32768
    s_cmp_eq_u32 s30, s40
    s_cselect_b32 s30, s42, s30
    s_lshr_b32 s33, s35, 1
    s_lshl_b32 s29, s33, 2
    s_lshr_b64 s[88:89], s[96:97], s29
    s_and_b32 s39, s88, 15
    s_lshl_b32 s39, s39, 1
    s_and_b32 s29, s35, 1
    s_add_u32 s39, s39, s29
    s_mul_i32 s39, s39, 196608
    s_add_u32 s35, s35, 1
    s_add_u32 m0, s31, 0
    s_nop 0
    buffer_load_dwordx4 v16, s[12:15], s39 offen lds
    s_add_u32 m0, s31, 4096
    s_nop 0
    buffer_load_dwordx4 v17, s[12:15], s39 offen lds
    s_add_u32 m0, s31, 8192
    s_nop 0
    buffer_load_dwordx4 v18, s[12:15], s39 offen lds
    s_add_u32 s31, s31, 12288
    s_cmp_eq_u32 s31, s41
    s_cselect_b32 s31, s37, s31
    s_lshl_b32 s29, s26, 12
    s_add_u32 s29, s29, s37
    s_add_u32 m0, s37, 159744
    s_nop 0
    buffer_load_dwordx4 v19, s[20:23], s29 offen lds
    s_and_b32 s29, s27, 3
    s_lshl_b32 s29, s29, 13
    v_lshlrev_b32 v249, 7, v0
    v_add_u32 v249, s29, v249
    v_min_u32 v249, L_end-L_pc, v249
    global_load_dword v249, v249, s[94:95]
    s_waitcnt vmcnt(19)
    s_barrier
    s_lshl_b32 s34, s26, 1
    s_add_u32 s34, s34, 1
    s_sub_u32 s34, s34, s24
    s_and_b32 s31, s27, 3
    s_lshl_b32 s35, s25, 3
    s_lshl_b32 s29, s31, 1
    s_add_u32 s35, s35, s29
    s_mul_i32 s40, s34, 268288
    s_add_u32 s40, s40, 33554432
    v_lshlrev_b32 v1, 4, v0
    s_add_u32 s29, s25, s26
    s_and_b32 s29, s29, 3
    s_mov_b32 s51, 73757203
    s_cmp_eq_u32 s29, 1
    s_cselect_b32 s51, 67524387, s51
    s_cmp_eq_u32 s29, 2
    s_cselect_b32 s51, 67524371, s51
    s_cmp_eq_u32 s29, 3
    s_cselect_b32 s51, 67524385, s51
    s_lshl_b32 s41, s31, 13
    s_add_u32 s40, s40, s41
    s_mov_b32 s43, s41
    s_mov_b32 s93, s25
    s_mov_b32 s44, 1069066811
    s_mov_b32 s45, 1069066811
    s_lshr_b32 s50, s2, 4
    s_lshl_b32 s50, s50, 17
    s_lshl_b32 s37, s31, 15
    s_add_u32 s50, s50, s37
    s_and_b32 s37, s3, 4
    s_lshl_b32 s37, s37, 8
    s_add_u32 s50, s50, s37
    v_lshrrev_b32 v3, 3, v0
    v_and_b32 v2, 7, v0
    v_lshlrev_b32 v3, 11, v3
    v_lshl_add_u32 v3, v2, 7, v3
    s_lshl_b32 s38, s26, 1
    s_add_u32 s38, s38, 1
    s_lshl_b32 s38, s38, 6
    s_add_u32 s38, s38, s35
    s_lshr_b32 s29, s38, 3
    s_mul_i32 s29, s29, 768
    s_lshl_b32 s38, s38, 11
    s_add_u32 s38, s38, s29
    s_add_u32 s38, s38, 46137344
    s_waitcnt vmcnt(16)
    s_barrier
    s_waitcnt vmcnt(5)
    s_barrier
    s_waitcnt vmcnt(1)
    s_mov_b32 s90, 0x40000
L_arr_p:
    v_cmp_gt_u32 vcc, 256, v30
    s_sub_u32 s90, s90, 1
    s_cbranch_scc1 L_arr_d
    s_cbranch_vccz L_arr_d
    s_sleep 1
    buffer_load_dword v30, v31, s[84:87], 0 offen sc0 sc1
    s_waitcnt vmcnt(0)
    s_branch L_arr_p
L_arr_d:
    s_barrier
    v_mov_b32 v247, v3
    s_mov_b32 s91, 0
    s_cmp_lg_u32 s24, 0
    s_cbranch_scc1 L_p1_hB
    s_and_b32 s37, s27, 1
    s_and_b32 s29, s27, 3
    s_mul_i32 s29, s29, 4096
    v_add_u32 v5, s29, v1
    s_mov_b32 s44, 1069066811
    s_mov_b32 s45, 1069066811
    v_lshrrev_b32 v2, 5, v0
    v_bfe_u32 v3, v0, 2, 2
    v_lshl_add_u32 v3, v2, 2, v3
    v_bfe_u32 v4, v0, 4, 1
    v_lshlrev_b32 v4, 5, v4
    v_and_b32 v7, 3, v0
    v_lshl_add_u32 v4, v7, 3, v4
    v_lshl_add_u32 v7, v3, 6, v4
    s_lshl_b32 s29, s37, 11
    s_add_u32 s29, s29, 159744
    v_add_u32 v7, s29, v7
    ds_read_b64_tr_b16 v[8:9], v7 offset:0
    ds_read_b64_tr_b16 v[10:11], v7 offset:1024
    ds_read_b64_tr_b16 v[12:13], v7 offset:512
    ds_read_b64_tr_b16 v[14:15], v7 offset:1536
    s_and_b32 s46, s27, 3
    s_mul_i32 s46, s46, 17408
    s_add_u32 s46, s46, 65536
    v_and_b32 v6, 31, v0
    v_mul_u32_u24 v6, 136, v6
    v_lshl_add_u32 v6, v2, 3, v6
    v_add_u32 v6, s46, v6
    v_mul_u32_u24 v7, 136, v3
    v_add3_u32 v7, v7, v4, s46
    s_barrier
    s_barrier
    ds_read_b128 v[64:67], v5 offset:0
    ds_read_b128 v[68:71], v5 offset:1024
    ds_read_b128 v[72:75], v5 offset:2048
    ds_read_b128 v[76:79], v5 offset:3072
    s_waitcnt lgkmcnt(2)
    v_mfma_f32_32x32x16_bf16 v[96:111], v[8:11], v[64:67], 0
    v_mfma_f32_32x32x16_bf16 v[96:111], v[12:15], v[68:71], v[96:111]
    s_waitcnt lgkmcnt(0)
    v_mfma_f32_32x32x16_bf16 v[112:127], v[8:11], v[72:75], 0
    v_mfma_f32_32x32x16_bf16 v[112:127], v[12:15], v[76:79], v[112:127]
    s_nop 8
    v_max3_f32 v20, v96, v97, v98
    v_min3_f32 v21, v96, v97, v98
    v_max3_f32 v20, v20, v99, v100
    v_min3_f32 v21, v21, v99, v100
    v_max3_f32 v20, v20, v101, v102
    v_min3_f32 v21, v21, v101, v102
    v_max3_f32 v20, v20, v103, v104
    v_min3_f32 v21, v21, v103, v104
    v_max3_f32 v20, v20, v105, v106
    v_min3_f32 v21, v21, v105, v106
    v_max3_f32 v20, v20, v107, v108
    v_min3_f32 v21, v21, v107, v108
    v_max3_f32 v20, v20, v109, v110
    v_min3_f32 v21, v21, v109, v110
    v_max_f32 v20, v20, v111
    v_min_f32 v21, v21, v111
    v_mov_b32 v22, v20
    v_mov_b32 v23, v21
    s_nop 0
    v_permlane32_swap_b32 v20, v22
    v_permlane32_swap_b32 v21, v23
    v_max_f32 v20, v20, v22
    v_min_f32 v21, v21, v23
    v_mul_f32 v24, s44, v20
    v_mul_f32 v26, s44, v21
    v_pk_fma_f32 v[128:129], v[96:97], s[44:45], v[24:25] op_sel_hi:[1,1,0] neg_lo:[0,0,1] neg_hi:[0,0,1]
    v_pk_fma_f32 v[130:131], v[98:99], s[44:45], v[24:25] op_sel_hi:[1,1,0] neg_lo:[0,0,1] neg_hi:[0,0,1]
    v_pk_fma_f32 v[132:133], v[100:101], s[44:45], v[24:25] op_sel_hi:[1,1,0] neg_lo:[0,0,1] neg_hi:[0,0,1]
    v_pk_fma_f32 v[134:135], v[102:103], s[44:45], v[24:25] op_sel_hi:[1,1,0] neg_lo:[0,0,1] neg_hi:[0,0,1]
    v_pk_fma_f32 v[136:137], v[104:105], s[44:45], v[24:25] op_sel_hi:[1,1,0] neg_lo:[0,0,1] neg_hi:[0,0,1]
    v_pk_fma_f32 v[138:139], v[106:107], s[44:45], v[24:25] op_sel_hi:[1,1,0] neg_lo:[0,0,1] neg_hi:[0,0,1]
    v_pk_fma_f32 v[140:141], v[108:109], s[44:45], v[24:25] op_sel_hi:[1,1,0] neg_lo:[0,0,1] neg_hi:[0,0,1]
    v_pk_fma_f32 v[142:143], v[110:111], s[44:45], v[24:25] op_sel_hi:[1,1,0] neg_lo:[0,0,1] neg_hi:[0,0,1]
    v_pk_fma_f32 v[96:97], v[96:97], s[44:45], v[26:27] op_sel_hi:[1,1,0] neg_lo:[1,0,0] neg_hi:[1,0,0]
    v_pk_fma_f32 v[98:99], v[98:99], s[44:45], v[26:27] op_sel_hi:[1,1,0] neg_lo:[1,0,0] neg_hi:[1,0,0]
    v_pk_fma_f32 v[100:101], v[100:101], s[44:45], v[26:27] op_sel_hi:[1,1,0] neg_lo:[1,0,0] neg_hi:[1,0,0]
    v_pk_fma_f32 v[102:103], v[102:103], s[44:45], v[26:27] op_sel_hi:[1,1,0] neg_lo:[1,0,0] neg_hi:[1,0,0]
    v_pk_fma_f32 v[104:105], v[104:105], s[44:45], v[26:27] op_sel_hi:[1,1,0] neg_lo:[1,0,0] neg_hi:[1,0,0]
    v_pk_fma_f32 v[106:107], v[106:107], s[44:45], v[26:27] op_sel_hi:[1,1,0] neg_lo:[1,0,0] neg_hi:[1,0,0]
    v_pk_fma_f32 v[108:109], v[108:109], s[44:45], v[26:27] op_sel_hi:[1,1,0] neg_lo:[1,0,0] neg_hi:[1,0,0]
    v_pk_fma_f32 v[110:111], v[110:111], s[44:45], v[26:27] op_sel_hi:[1,1,0] neg_lo:[1,0,0] neg_hi:[1,0,0]
    v_exp_f32 v128, v128
    v_exp_f32 v129, v129
    v_exp_f32 v130, v130
    v_exp_f32 v131, v131
    v_exp_f32 v132, v132
    v_exp_f32 v133, v133
    v_exp_f32 v134, v134
    v_exp_f32 v135, v135
    v_exp_f32 v136, v136
    v_exp_f32 v137, v137
    v_exp_f32 v138, v138
    v_exp_f32 v139, v139
    v_exp_f32 v140, v140
    v_exp_f32 v141, v141
    v_exp_f32 v142, v142
    v_exp_f32 v143, v143
    v_exp_f32 v96, v96
    v_exp_f32 v97, v97
    v_exp_f32 v98, v98
    v_exp_f32 v99, v99
    v_exp_f32 v100, v100
    v_exp_f32 v101, v101
    v_exp_f32 v102, v102
    v_exp_f32 v103, v103
    v_exp_f32 v104, v104
    v_exp_f32 v105, v105
    v_exp_f32 v106, v106
    v_exp_f32 v107, v107
    v_exp_f32 v108, v108
    v_exp_f32 v109, v109
    v_exp_f32 v110, v110
    v_exp_f32 v111, v111
    v_pk_add_f32 v[28:29], v[128:129], v[130:131]
    v_pk_add_f32 v[30:31], v[96:97], v[98:99]
    v_pk_add_f32 v[28:29], v[28:29], v[132:133]
    v_pk_add_f32 v[30:31], v[30:31], v[100:101]
    v_pk_add_f32 v[28:29], v[28:29], v[134:135]
    v_pk_add_f32 v[30:31], v[30:31], v[102:103]
    v_pk_add_f32 v[28:29], v[28:29], v[136:137]
    v_pk_add_f32 v[30:31], v[30:31], v[104:105]
    v_pk_add_f32 v[28:29], v[28:29], v[138:139]
    v_pk_add_f32 v[30:31], v[30:31], v[106:107]
    v_pk_add_f32 v[28:29], v[28:29], v[140:141]
    v_pk_add_f32 v[30:31], v[30:31], v[108:109]
    v_pk_add_f32 v[28:29], v[28:29], v[142:143]
    v_pk_add_f32 v[30:31], v[30:31], v[110:111]
    v_add_f32 v28, v28, v29
    v_add_f32 v30, v30, v31
    v_mov_b32 v22, v28
    v_mov_b32 v23, v30
    s_nop 0
    v_permlane32_swap_b32 v28, v22
    v_permlane32_swap_b32 v30, v23
    v_add_f32 v28, v28, v22
    v_add_f32 v30, v30, v23
    v_rcp_f32 v28, v28
    v_rcp_f32 v30, v30
    v_pk_mul_f32 v[128:129], v[128:129], v[28:29] op_sel_hi:[1,0]
    v_pk_mul_f32 v[130:131], v[130:131], v[28:29] op_sel_hi:[1,0]
    v_pk_mul_f32 v[132:133], v[132:133], v[28:29] op_sel_hi:[1,0]
    v_pk_mul_f32 v[134:135], v[134:135], v[28:29] op_sel_hi:[1,0]
    v_pk_mul_f32 v[136:137], v[136:137], v[28:29] op_sel_hi:[1,0]
    v_pk_mul_f32 v[138:139], v[138:139], v[28:29] op_sel_hi:[1,0]
    v_pk_mul_f32 v[140:141], v[140:141], v[28:29] op_sel_hi:[1,0]
    v_pk_mul_f32 v[142:143], v[142:143], v[28:29] op_sel_hi:[1,0]
    v_pk_mul_f32 v[96:97], v[96:97], v[30:31] op_sel_hi:[1,0]
    v_pk_mul_f32 v[98:99], v[98:99], v[30:31] op_sel_hi:[1,0]
    v_pk_mul_f32 v[100:101], v[100:101], v[30:31] op_sel_hi:[1,0]
    v_pk_mul_f32 v[102:103], v[102:103], v[30:31] op_sel_hi:[1,0]
    v_pk_mul_f32 v[104:105], v[104:105], v[30:31] op_sel_hi:[1,0]
    v_pk_mul_f32 v[106:107], v[106:107], v[30:31] op_sel_hi:[1,0]
    v_pk_mul_f32 v[108:109], v[108:109], v[30:31] op_sel_hi:[1,0]
    v_pk_mul_f32 v[110:111], v[110:111], v[30:31] op_sel_hi:[1,0]
    v_cvt_pk_bf16_f32 v128, v128, v129
    v_cvt_pk_bf16_f32 v129, v130, v131
    v_cvt_pk_bf16_f32 v130, v132, v133
    v_cvt_pk_bf16_f32 v131, v134, v135
    v_cvt_pk_bf16_f32 v132, v136, v137
    v_cvt_pk_bf16_f32 v133, v138, v139
    v_cvt_pk_bf16_f32 v134, v140, v141
    v_cvt_pk_bf16_f32 v135, v142, v143
    v_cvt_pk_bf16_f32 v96, v96, v97
    v_cvt_pk_bf16_f32 v97, v98, v99
    v_cvt_pk_bf16_f32 v98, v100, v101
    v_cvt_pk_bf16_f32 v99, v102, v103
    v_cvt_pk_bf16_f32 v100, v104, v105
    v_cvt_pk_bf16_f32 v101, v106, v107
    v_cvt_pk_bf16_f32 v102, v108, v109
    v_cvt_pk_bf16_f32 v103, v110, v111
    ds_write_b64 v6, v[128:129] offset:0
    ds_write_b64 v6, v[130:131] offset:16
    ds_write_b64 v6, v[132:133] offset:32
    ds_write_b64 v6, v[134:135] offset:48
    ds_write_b64 v6, v[96:97] offset:64
    ds_write_b64 v6, v[98:99] offset:80
    ds_write_b64 v6, v[100:101] offset:96
    ds_write_b64 v6, v[102:103] offset:112
    v_max3_f32 v20, v112, v113, v114
    v_min3_f32 v21, v112, v113, v114
    v_max3_f32 v20, v20, v115, v116
    v_min3_f32 v21, v21, v115, v116
    v_max3_f32 v20, v20, v117, v118
    v_min3_f32 v21, v21, v117, v118
    v_max3_f32 v20, v20, v119, v120
    v_min3_f32 v21, v21, v119, v120
    v_max3_f32 v20, v20, v121, v122
    v_min3_f32 v21, v21, v121, v122
    v_max3_f32 v20, v20, v123, v124
    v_min3_f32 v21, v21, v123, v124
    v_max3_f32 v20, v20, v125, v126
    v_min3_f32 v21, v21, v125, v126
    v_max_f32 v20, v20, v127
    v_min_f32 v21, v21, v127
    v_mov_b32 v22, v20
    v_mov_b32 v23, v21
    s_nop 0
    v_permlane32_swap_b32 v20, v22
    v_permlane32_swap_b32 v21, v23
    v_max_f32 v20, v20, v22
    v_min_f32 v21, v21, v23
    v_mul_f32 v24, s44, v20
    v_mul_f32 v26, s44, v21
    v_pk_fma_f32 v[144:145], v[112:113], s[44:45], v[24:25] op_sel_hi:[1,1,0] neg_lo:[0,0,1] neg_hi:[0,0,1]
    v_pk_fma_f32 v[146:147], v[114:115], s[44:45], v[24:25] op_sel_hi:[1,1,0] neg_lo:[0,0,1] neg_hi:[0,0,1]
    v_pk_fma_f32 v[148:149], v[116:117], s[44:45], v[24:25] op_sel_hi:[1,1,0] neg_lo:[0,0,1] neg_hi:[0,0,1]
    v_pk_fma_f32 v[150:151], v[118:119], s[44:45], v[24:25] op_sel_hi:[1,1,0] neg_lo:[0,0,1] neg_hi:[0,0,1]
    v_pk_fma_f32 v[152:153], v[120:121], s[44:45], v[24:25] op_sel_hi:[1,1,0] neg_lo:[0,0,1] neg_hi:[0,0,1]
    v_pk_fma_f32 v[154:155], v[122:123], s[44:45], v[24:25] op_sel_hi:[1,1,0] neg_lo:[0,0,1] neg_hi:[0,0,1]
    v_pk_fma_f32 v[156:157], v[124:125], s[44:45], v[24:25] op_sel_hi:[1,1,0] neg_lo:[0,0,1] neg_hi:[0,0,1]
    v_pk_fma_f32 v[158:159], v[126:127], s[44:45], v[24:25] op_sel_hi:[1,1,0] neg_lo:[0,0,1] neg_hi:[0,0,1]
    v_pk_fma_f32 v[112:113], v[112:113], s[44:45], v[26:27] op_sel_hi:[1,1,0] neg_lo:[1,0,0] neg_hi:[1,0,0]
    v_pk_fma_f32 v[114:115], v[114:115], s[44:45], v[26:27] op_sel_hi:[1,1,0] neg_lo:[1,0,0] neg_hi:[1,0,0]
    v_pk_fma_f32 v[116:117], v[116:117], s[44:45], v[26:27] op_sel_hi:[1,1,0] neg_lo:[1,0,0] neg_hi:[1,0,0]
    v_pk_fma_f32 v[118:119], v[118:119], s[44:45], v[26:27] op_sel_hi:[1,1,0] neg_lo:[1,0,0] neg_hi:[1,0,0]
    v_pk_fma_f32 v[120:121], v[120:121], s[44:45], v[26:27] op_sel_hi:[1,1,0] neg_lo:[1,0,0] neg_hi:[1,0,0]
    v_pk_fma_f32 v[122:123], v[122:123], s[44:45], v[26:27] op_sel_hi:[1,1,0] neg_lo:[1,0,0] neg_hi:[1,0,0]
    v_pk_fma_f32 v[124:125], v[124:125], s[44:45], v[26:27] op_sel_hi:[1,1,0] neg_lo:[1,0,0] neg_hi:[1,0,0]
    v_pk_fma_f32 v[126:127], v[126:127], s[44:45], v[26:27] op_sel_hi:[1,1,0] neg_lo:[1,0,0] neg_hi:[1,0,0]
    v_exp_f32 v144, v144
    v_exp_f32 v145, v145
    v_exp_f32 v146, v146
    v_exp_f32 v147, v147
    v_exp_f32 v148, v148
    v_exp_f32 v149, v149
    v_exp_f32 v150, v150
    v_exp_f32 v151, v151
    v_exp_f32 v152, v152
    v_exp_f32 v153, v153
    v_exp_f32 v154, v154
    v_exp_f32 v155, v155
    v_exp_f32 v156, v156
    v_exp_f32 v157, v157
    v_exp_f32 v158, v158
    v_exp_f32 v159, v159
    v_exp_f32 v112, v112
    v_exp_f32 v113, v113
    v_exp_f32 v114, v114
    v_exp_f32 v115, v115
    v_exp_f32 v116, v116
    v_exp_f32 v117, v117
    v_exp_f32 v118, v118
    v_exp_f32 v119, v119
    v_exp_f32 v120, v120
    v_exp_f32 v121, v121
    v_exp_f32 v122, v122
    v_exp_f32 v123, v123
    v_exp_f32 v124, v124
    v_exp_f32 v125, v125
    v_exp_f32 v126, v126
    v_exp_f32 v127, v127
    v_pk_add_f32 v[28:29], v[144:145], v[146:147]
    v_pk_add_f32 v[30:31], v[112:113], v[114:115]
    v_pk_add_f32 v[28:29], v[28:29], v[148:149]
    v_pk_add_f32 v[30:31], v[30:31], v[116:117]
    v_pk_add_f32 v[28:29], v[28:29], v[150:151]
    v_pk_add_f32 v[30:31], v[30:31], v[118:119]
    v_pk_add_f32 v[28:29], v[28:29], v[152:153]
    v_pk_add_f32 v[30:31], v[30:31], v[120:121]
    v_pk_add_f32 v[28:29], v[28:29], v[154:155]
    v_pk_add_f32 v[30:31], v[30:31], v[122:123]
    v_pk_add_f32 v[28:29], v[28:29], v[156:157]
    v_pk_add_f32 v[30:31], v[30:31], v[124:125]
    v_pk_add_f32 v[28:29], v[28:29], v[158:159]
    v_pk_add_f32 v[30:31], v[30:31], v[126:127]
    v_add_f32 v28, v28, v29
    v_add_f32 v30, v30, v31
    v_mov_b32 v22, v28
    v_mov_b32 v23, v30
    s_nop 0
    v_permlane32_swap_b32 v28, v22
    v_permlane32_swap_b32 v30, v23
    v_add_f32 v28, v28, v22
    v_add_f32 v30, v30, v23
    v_rcp_f32 v28, v28
    v_rcp_f32 v30, v30
    v_pk_mul_f32 v[144:145], v[144:145], v[28:29] op_sel_hi:[1,0]
    v_pk_mul_f32 v[146:147], v[146:147], v[28:29] op_sel_hi:[1,0]
    v_pk_mul_f32 v[148:149], v[148:149], v[28:29] op_sel_hi:[1,0]
    v_pk_mul_f32 v[150:151], v[150:151], v[28:29] op_sel_hi:[1,0]
    v_pk_mul_f32 v[152:153], v[152:153], v[28:29] op_sel_hi:[1,0]
    v_pk_mul_f32 v[154:155], v[154:155], v[28:29] op_sel_hi:[1,0]
    v_pk_mul_f32 v[156:157], v[156:157], v[28:29] op_sel_hi:[1,0]
    v_pk_mul_f32 v[158:159], v[158:159], v[28:29] op_sel_hi:[1,0]
    v_pk_mul_f32 v[112:113], v[112:113], v[30:31] op_sel_hi:[1,0]
    v_pk_mul_f32 v[114:115], v[114:115], v[30:31] op_sel_hi:[1,0]
    v_pk_mul_f32 v[116:117], v[116:117], v[30:31] op_sel_hi:[1,0]
    v_pk_mul_f32 v[118:119], v[118:119], v[30:31] op_sel_hi:[1,0]
    v_pk_mul_f32 v[120:121], v[120:121], v[30:31] op_sel_hi:[1,0]
    v_pk_mul_f32 v[122:123], v[122:123], v[30:31] op_sel_hi:[1,0]
    v_pk_mul_f32 v[124:125], v[124:125], v[30:31] op_sel_hi:[1,0]
    v_pk_mul_f32 v[126:127], v[126:127], v[30:31] op_sel_hi:[1,0]
    v_cvt_pk_bf16_f32 v144, v144, v145
    v_cvt_pk_bf16_f32 v145, v146, v147
    v_cvt_pk_bf16_f32 v146, v148, v149
    v_cvt_pk_bf16_f32 v147, v150, v151
    v_cvt_pk_bf16_f32 v148, v152, v153
    v_cvt_pk_bf16_f32 v149, v154, v155
    v_cvt_pk_bf16_f32 v150, v156, v157
    v_cvt_pk_bf16_f32 v151, v158, v159
    v_cvt_pk_bf16_f32 v112, v112, v113
    v_cvt_pk_bf16_f32 v113, v114, v115
    v_cvt_pk_bf16_f32 v114, v116, v117
    v_cvt_pk_bf16_f32 v115, v118, v119
    v_cvt_pk_bf16_f32 v116, v120, v121
    v_cvt_pk_bf16_f32 v117, v122, v123
    v_cvt_pk_bf16_f32 v118, v124, v125
    v_cvt_pk_bf16_f32 v119, v126, v127
    ds_write_b64 v6, v[144:145] offset:4352
    ds_write_b64 v6, v[146:147] offset:4368
    ds_write_b64 v6, v[148:149] offset:4384
    ds_write_b64 v6, v[150:151] offset:4400
    ds_write_b64 v6, v[112:113] offset:4416
    ds_write_b64 v6, v[114:115] offset:4432
    ds_write_b64 v6, v[116:117] offset:4448
    ds_write_b64 v6, v[118:119] offset:4464
    s_waitcnt lgkmcnt(0)
    s_setprio 0
L_p1_hB:
    s_barrier
L_p1_hdone:
    s_cmp_lg_u32 s24, 0
    s_cbranch_scc1 L_p2_hB
    s_mov_b32 s88, 0
    s_mov_b32 s89, 3145728
    s_mov_b32 s90, 0x40000
    s_mov_b64 exec, s[88:89]
L_pl_2p:
    buffer_load_dword v252, v251, s[16:19], 0 offen sc0 sc1
    s_waitcnt vmcnt(0)
    v_sub_u32 v252, v252, v250
    v_cmp_ne_u32 vcc, 1, v252
    s_sub_u32 s90, s90, 1
    s_cbranch_scc1 L_pl_2d
    s_cbranch_vccz L_pl_2d
    s_sleep 1
    s_branch L_pl_2p
L_pl_2d:
    s_mov_b64 exec, -1
L_pl_2:
    s_lshl_b32 s29, s31, 12
    s_add_u32 m0, s29, 139264
    s_mul_i32 s42, s93, 33536
    s_add_u32 s42, s42, s40
    s_sub_u32 s42, s42, s29
    buffer_load_dwordx4 v1, s[16:19], s38 offen offset:0 sc1 lds
    buffer_load_dwordx4 v1, s[16:19], s38 offen offset:1024 sc1 lds
    buffer_load_dwordx4 v1, s[16:19], s38 offen offset:2048 sc1 lds
    buffer_load_dwordx4 v1, s[16:19], s38 offen offset:3072 sc1 lds
    s_mov_b32 m0, s29
    s_nop 0
    buffer_load_dwordx4 v1, s[16:19], s42 offen offset:0 sc1 lds
    buffer_load_dwordx4 v1, s[16:19], s42 offen offset:1024 sc1 lds
    buffer_load_dwordx4 v1, s[16:19], s42 offen offset:2048 sc1 lds
    buffer_load_dwordx4 v1, s[16:19], s42 offen offset:3072 sc1 lds
    s_add_u32 m0, s29, 16384
    s_add_u32 s42, s42, 16384
    buffer_load_dwordx4 v1, s[16:19], s42 offen offset:0 sc1 lds
    buffer_load_dwordx4 v1, s[16:19], s42 offen offset:1024 sc1 lds
    buffer_load_dwordx4 v1, s[16:19], s42 offen offset:2048 sc1 lds
    buffer_load_dwordx4 v1, s[16:19], s42 offen offset:3072 sc1 lds
    s_sub_u32 s93, s51, s26
    s_and_b32 s93, s93, 3
    s_xor_b32 s29, s51, s25
    s_and_b32 s29, s29, 4
    s_or_b32 s93, s93, s29
    s_lshr_b32 s51, s51, 4
    s_add_u32 s43, s43, 32768
    s_and_b32 s43, s43, 131071
    s_waitcnt vmcnt(4)
    s_barrier
    s_mov_b64 exec, 0xff
    buffer_load_dword v252, v251, s[16:19], 0 offen sc0 sc1
    s_waitcnt vmcnt(1)
    s_barrier
    s_waitcnt vmcnt(0)
    v_cmp_ne_u32 vcc, v252, v250
    s_mov_b64 exec, -1
    s_mov_b32 s92, vcc_lo
    s_bitcmp1_b32 s92, s93
    s_cbranch_scc1 L_nc_3
    s_mov_b32 s90, 0x40000
    s_lshl_b64 s[88:89], 1, s93
    s_mov_b64 exec, 0xff
L_nc_3p:
    buffer_load_dword v252, v251, s[16:19], 0 offen sc0 sc1
    s_waitcnt vmcnt(0)
    v_cmp_ne_u32 vcc, v252, v250
    s_sub_u32 s90, s90, 1
    s_cbranch_scc1 L_nc_3d
    s_or_b32 s92, s92, vcc_lo
    s_mov_b64 exec, s[88:89]
    s_bitcmp1_b32 s92, s93
    s_cbranch_scc1 L_nc_3d
    s_sleep 2
    s_branch L_nc_3p
L_nc_3d:
    s_mov_b64 exec, -1
L_nc_3:
    s_mul_i32 s42, s93, 33536
    s_add_u32 s42, s42, s40
    s_add_u32 m0, s43, 0
    s_add_u32 s29, s42, 0
    buffer_load_dwordx4 v1, s[16:19], s29 offen offset:0 sc1 lds
    buffer_load_dwordx4 v1, s[16:19], s29 offen offset:1024 sc1 lds
    buffer_load_dwordx4 v1, s[16:19], s29 offen offset:2048 sc1 lds
    buffer_load_dwordx4 v1, s[16:19], s29 offen offset:3072 sc1 lds
    s_add_u32 m0, s43, 4096
    s_add_u32 s29, s42, 4096
    buffer_load_dwordx4 v1, s[16:19], s29 offen offset:0 sc1 lds
    buffer_load_dwordx4 v1, s[16:19], s29 offen offset:1024 sc1 lds
    buffer_load_dwordx4 v1, s[16:19], s29 offen offset:2048 sc1 lds
    buffer_load_dwordx4 v1, s[16:19], s29 offen offset:3072 sc1 lds
    s_sub_u32 s93, s51, s26
    s_and_b32 s93, s93, 3
    s_xor_b32 s29, s51, s25
    s_and_b32 s29, s29, 4
    s_or_b32 s93, s93, s29
    s_lshr_b32 s51, s51, 4
    s_add_u32 s43, s43, 32768
    s_and_b32 s43, s43, 131071
    s_waitcnt vmcnt(0)
    s_barrier
    s_bitcmp1_b32 s92, s93
    s_cbranch_scc1 L_nc_4
    s_mov_b32 s90, 0x40000
    s_lshl_b64 s[88:89], 1, s93
    s_mov_b64 exec, 0xff
L_nc_4p:
    buffer_load_dword v252, v251, s[16:19], 0 offen sc0 sc1
    s_waitcnt vmcnt(0)
    v_cmp_ne_u32 vcc, v252, v250
    s_sub_u32 s90, s90, 1
    s_cbranch_scc1 L_nc_4d
    s_or_b32 s92, s92, vcc_lo
    s_mov_b64 exec, s[88:89]
    s_bitcmp1_b32 s92, s93
    s_cbranch_scc1 L_nc_4d
    s_sleep 2
    s_branch L_nc_4p
L_nc_4d:
    s_mov_b64 exec, -1
L_nc_4:
    s_mul_i32 s42, s93, 33536
    s_add_u32 s42, s42, s40
    s_add_u32 m0, s43, 0
    s_add_u32 s29, s42, 0
    buffer_load_dwordx4 v1, s[16:19], s29 offen offset:0 sc1 lds
    buffer_load_dwordx4 v1, s[16:19], s29 offen offset:1024 sc1 lds
    buffer_load_dwordx4 v1, s[16:19], s29 offen offset:2048 sc1 lds
    buffer_load_dwordx4 v1, s[16:19], s29 offen offset:3072 sc1 lds
    s_add_u32 m0, s43, 4096
    s_add_u32 s29, s42, 4096
    buffer_load_dwordx4 v1, s[16:19], s29 offen offset:0 sc1 lds
    buffer_load_dwordx4 v1, s[16:19], s29 offen offset:1024 sc1 lds
    buffer_load_dwordx4 v1, s[16:19], s29 offen offset:2048 sc1 lds
    buffer_load_dwordx4 v1, s[16:19], s29 offen offset:3072 sc1 lds
    s_sub_u32 s93, s51, s26
    s_and_b32 s93, s93, 3
    s_xor_b32 s29, s51, s25
    s_and_b32 s29, s29, 4
    s_or_b32 s93, s93, s29
    s_lshr_b32 s51, s51, 4
    s_add_u32 s43, s43, 32768
    s_and_b32 s43, s43, 131071
    s_bitcmp1_b32 s92, s93
    s_cbranch_scc1 L_nc_5
    s_mov_b32 s90, 0x40000
    s_lshl_b64 s[88:89], 1, s93
    s_mov_b64 exec, 0xff
L_nc_5p:
    buffer_load_dword v252, v251, s[16:19], 0 offen sc0 sc1
    s_waitcnt vmcnt(0)
    v_cmp_ne_u32 vcc, v252, v250
    s_sub_u32 s90, s90, 1
    s_cbranch_scc1 L_nc_5d
    s_or_b32 s92, s92, vcc_lo
    s_mov_b64 exec, s[88:89]
    s_bitcmp1_b32 s92, s93
    s_cbranch_scc1 L_nc_5d
    s_sleep 2
    s_branch L_nc_5p
L_nc_5d:
    s_mov_b64 exec, -1
L_nc_5:
    s_mul_i32 s42, s93, 33536
    s_add_u32 s42, s42, s40
    s_add_u32 m0, s43, 0
    s_add_u32 s29, s42, 0
    buffer_load_dwordx4 v1, s[16:19], s29 offen offset:0 sc1 lds
    buffer_load_dwordx4 v1, s[16:19], s29 offen offset:1024 sc1 lds
    buffer_load_dwordx4 v1, s[16:19], s29 offen offset:2048 sc1 lds
    buffer_load_dwordx4 v1, s[16:19], s29 offen offset:3072 sc1 lds
    s_add_u32 m0, s43, 4096
    s_add_u32 s29, s42, 4096
    buffer_load_dwordx4 v1, s[16:19], s29 offen offset:0 sc1 lds
    buffer_load_dwordx4 v1, s[16:19], s29 offen offset:1024 sc1 lds
    buffer_load_dwordx4 v1, s[16:19], s29 offen offset:2048 sc1 lds
    buffer_load_dwordx4 v1, s[16:19], s29 offen offset:3072 sc1 lds
    s_sub_u32 s93, s51, s26
    s_and_b32 s93, s93, 3
    s_xor_b32 s29, s51, s25
    s_and_b32 s29, s29, 4
    s_or_b32 s93, s93, s29
    s_lshr_b32 s51, s51, 4
    s_add_u32 s43, s43, 32768
    s_and_b32 s43, s43, 131071
    buffer_load_dword v96, v247, s[52:55], s50 offen
    s_add_u32 s50, s50, 16384
    s_waitcnt vmcnt(9)
    s_barrier
    s_bitcmp1_b32 s92, s93
    s_cbranch_scc1 L_nc_6
    s_mov_b32 s90, 0x40000
    s_lshl_b64 s[88:89], 1, s93
    s_mov_b64 exec, 0xff
L_nc_6p:
    buffer_load_dword v252, v251, s[16:19], 0 offen sc0 sc1
    s_waitcnt vmcnt(0)
    v_cmp_ne_u32 vcc, v252, v250
    s_sub_u32 s90, s90, 1
    s_cbranch_scc1 L_nc_6d
    s_or_b32 s92, s92, vcc_lo
    s_mov_b64 exec, s[88:89]
    s_bitcmp1_b32 s92, s93
    s_cbranch_scc1 L_nc_6d
    s_sleep 2
    s_branch L_nc_6p
L_nc_6d:
    s_mov_b64 exec, -1
L_nc_6:
    s_mul_i32 s42, s93, 33536
    s_add_u32 s42, s42, s40
    s_add_u32 m0, s43, 0
    s_add_u32 s29, s42, 0
    buffer_load_dwordx4 v1, s[16:19], s29 offen offset:0 sc1 lds
    buffer_load_dwordx4 v1, s[16:19], s29 offen offset:1024 sc1 lds
    buffer_load_dwordx4 v1, s[16:19], s29 offen offset:2048 sc1 lds
    buffer_load_dwordx4 v1, s[16:19], s29 offen offset:3072 sc1 lds
    s_add_u32 m0, s43, 4096
    s_add_u32 s29, s42, 4096
    buffer_load_dwordx4 v1, s[16:19], s29 offen offset:0 sc1 lds
    buffer_load_dwordx4 v1, s[16:19], s29 offen offset:1024 sc1 lds
    buffer_load_dwordx4 v1, s[16:19], s29 offen offset:2048 sc1 lds
    buffer_load_dwordx4 v1, s[16:19], s29 offen offset:3072 sc1 lds
    s_sub_u32 s93, s51, s26
    s_and_b32 s93, s93, 3
    s_xor_b32 s29, s51, s25
    s_and_b32 s29, s29, 4
    s_or_b32 s93, s93, s29
    s_lshr_b32 s51, s51, 4
    s_add_u32 s43, s43, 32768
    s_and_b32 s43, s43, 131071
    buffer_load_dword v96, v247, s[52:55], s50 offen
    s_add_u32 s50, s50, 16384
    s_waitcnt vmcnt(10)
    s_barrier
    s_bitcmp1_b32 s92, s93
    s_cbranch_scc1 L_nc_7
    s_mov_b32 s90, 0x40000
    s_lshl_b64 s[88:89], 1, s93
    s_mov_b64 exec, 0xff
L_nc_7p:
    buffer_load_dword v252, v251, s[16:19], 0 offen sc0 sc1
    s_waitcnt vmcnt(0)
    v_cmp_ne_u32 vcc, v252, v250
    s_sub_u32 s90, s90, 1
    s_cbranch_scc1 L_nc_7d
    s_or_b32 s92, s92, vcc_lo
    s_mov_b64 exec, s[88:89]
    s_bitcmp1_b32 s92, s93
    s_cbranch_scc1 L_nc_7d
    s_sleep 2
    s_branch L_nc_7p
L_nc_7d:
    s_mov_b64 exec, -1
L_nc_7:
    s_mul_i32 s42, s93, 33536
    s_add_u32 s42, s42, s40
    s_add_u32 m0, s43, 0
    s_add_u32 s29, s42, 0
    buffer_load_dwordx4 v1, s[16:19], s29 offen offset:0 sc1 lds
    buffer_load_dwordx4 v1, s[16:19], s29 offen offset:1024 sc1 lds
    buffer_load_dwordx4 v1, s[16:19], s29 offen offset:2048 sc1 lds
    buffer_load_dwordx4 v1, s[16:19], s29 offen offset:3072 sc1 lds
    s_add_u32 m0, s43, 4096
    s_add_u32 s29, s42, 4096
    buffer_load_dwordx4 v1, s[16:19], s29 offen offset:0 sc1 lds
    buffer_load_dwordx4 v1, s[16:19], s29 offen offset:1024 sc1 lds
    buffer_load_dwordx4 v1, s[16:19], s29 offen offset:2048 sc1 lds
    buffer_load_dwordx4 v1, s[16:19], s29 offen offset:3072 sc1 lds
    s_sub_u32 s93, s51, s26
    s_and_b32 s93, s93, 3
    s_xor_b32 s29, s51, s25
    s_and_b32 s29, s29, 4
    s_or_b32 s93, s93, s29
    s_lshr_b32 s51, s51, 4
    s_add_u32 s43, s43, 32768
    s_and_b32 s43, s43, 131071
    s_waitcnt vmcnt(9)
    s_barrier
    s_bitcmp1_b32 s92, s93
    s_cbranch_scc1 L_nc_8
    s_mov_b32 s90, 0x40000
    s_lshl_b64 s[88:89], 1, s93
    s_mov_b64 exec, 0xff
L_nc_8p:
    buffer_load_dword v252, v251, s[16:19], 0 offen sc0 sc1
    s_waitcnt vmcnt(0)
    v_cmp_ne_u32 vcc, v252, v250
    s_sub_u32 s90, s90, 1
    s_cbranch_scc1 L_nc_8d
    s_or_b32 s92, s92, vcc_lo
    s_mov_b64 exec, s[88:89]
    s_bitcmp1_b32 s92, s93
    s_cbranch_scc1 L_nc_8d
    s_sleep 2
    s_branch L_nc_8p
L_nc_8d:
    s_mov_b64 exec, -1
L_nc_8:
    s_mul_i32 s42, s93, 33536
    s_add_u32 s42, s42, s40
    s_add_u32 m0, s43, 0
    s_add_u32 s29, s42, 0
    buffer_load_dwordx4 v1, s[16:19], s29 offen offset:0 sc1 lds
    buffer_load_dwordx4 v1, s[16:19], s29 offen offset:1024 sc1 lds
    buffer_load_dwordx4 v1, s[16:19], s29 offen offset:2048 sc1 lds
    buffer_load_dwordx4 v1, s[16:19], s29 offen offset:3072 sc1 lds
    s_add_u32 m0, s43, 4096
    s_add_u32 s29, s42, 4096
    buffer_load_dwordx4 v1, s[16:19], s29 offen offset:0 sc1 lds
    buffer_load_dwordx4 v1, s[16:19], s29 offen offset:1024 sc1 lds
    buffer_load_dwordx4 v1, s[16:19], s29 offen offset:2048 sc1 lds
    buffer_load_dwordx4 v1, s[16:19], s29 offen offset:3072 sc1 lds
    s_sub_u32 s93, s51, s26
    s_and_b32 s93, s93, 3
    s_xor_b32 s29, s51, s25
    s_and_b32 s29, s29, 4
    s_or_b32 s93, s93, s29
    s_lshr_b32 s51, s51, 4
    s_add_u32 s43, s43, 32768
    s_and_b32 s43, s43, 131071
    s_waitcnt vmcnt(8)
    s_barrier
    s_bitcmp1_b32 s92, s93
    s_cbranch_scc1 L_nc_9
    s_mov_b32 s90, 0x40000
    s_lshl_b64 s[88:89], 1, s93
    s_mov_b64 exec, 0xff
L_nc_9p:
    buffer_load_dword v252, v251, s[16:19], 0 offen sc0 sc1
    s_waitcnt vmcnt(0)
    v_cmp_ne_u32 vcc, v252, v250
    s_sub_u32 s90, s90, 1
    s_cbranch_scc1 L_nc_9d
    s_or_b32 s92, s92, vcc_lo
    s_mov_b64 exec, s[88:89]
    s_bitcmp1_b32 s92, s93
    s_cbranch_scc1 L_nc_9d
    s_sleep 2
    s_branch L_nc_9p
L_nc_9d:
    s_mov_b64 exec, -1
L_nc_9:
    s_mul_i32 s42, s93, 33536
    s_add_u32 s42, s42, s40
    s_add_u32 m0, s43, 0
    s_add_u32 s29, s42, 0
    buffer_load_dwordx4 v1, s[16:19], s29 offen offset:0 sc1 lds
    buffer_load_dwordx4 v1, s[16:19], s29 offen offset:1024 sc1 lds
    buffer_load_dwordx4 v1, s[16:19], s29 offen offset:2048 sc1 lds
    buffer_load_dwordx4 v1, s[16:19], s29 offen offset:3072 sc1 lds
    s_add_u32 m0, s43, 4096
    s_add_u32 s29, s42, 4096
    buffer_load_dwordx4 v1, s[16:19], s29 offen offset:0 sc1 lds
    buffer_load_dwordx4 v1, s[16:19], s29 offen offset:1024 sc1 lds
    buffer_load_dwordx4 v1, s[16:19], s29 offen offset:2048 sc1 lds
    buffer_load_dwordx4 v1, s[16:19], s29 offen offset:3072 sc1 lds
    s_sub_u32 s93, s51, s26
    s_and_b32 s93, s93, 3
    s_xor_b32 s29, s51, s25
    s_and_b32 s29, s29, 4
    s_or_b32 s93, s93, s29
    s_lshr_b32 s51, s51, 4
    s_add_u32 s43, s43, 32768
    s_and_b32 s43, s43, 131071
    s_waitcnt vmcnt(8)
    s_branch L_p2_hjoin
L_p2_hB:
    v_add_u32 v2, s41, v1
    s_mul_i32 s42, s25, 33536
    s_add_u32 s42, s42, s40
    s_add_u32 s46, s42, 4096
    s_barrier
    s_setprio 2
    ds_read_b128 v[8:11], v2 offset:0
    ds_read_b128 v[12:15], v2 offset:1024
    ds_read_b128 v[16:19], v2 offset:2048
    ds_read_b128 v[20:23], v2 offset:3072
    ds_read_b128 v[24:27], v2 offset:4096
    ds_read_b128 v[28:31], v2 offset:5120
    ds_read_b128 v[32:35], v2 offset:6144
    ds_read_b128 v[36:39], v2 offset:7168
    s_barrier
    s_waitcnt lgkmcnt(7)
    buffer_store_dwordx4 v[8:11], v1, s[16:19], s42 offen offset:0 sc0 sc1
    s_waitcnt lgkmcnt(6)
    buffer_store_dwordx4 v[12:15], v1, s[16:19], s42 offen offset:1024 sc0 sc1
    s_waitcnt lgkmcnt(5)
    buffer_store_dwordx4 v[16:19], v1, s[16:19], s42 offen offset:2048 sc0 sc1
    s_waitcnt lgkmcnt(4)
    buffer_store_dwordx4 v[20:23], v1, s[16:19], s42 offen offset:3072 sc0 sc1
    s_waitcnt lgkmcnt(3)
    buffer_store_dwordx4 v[24:27], v1, s[16:19], s46 offen offset:0 sc0 sc1
    s_waitcnt lgkmcnt(2)
    buffer_store_dwordx4 v[28:31], v1, s[16:19], s46 offen offset:1024 sc0 sc1
    s_waitcnt lgkmcnt(1)
    buffer_store_dwordx4 v[32:35], v1, s[16:19], s46 offen offset:2048 sc0 sc1
    s_waitcnt lgkmcnt(0)
    buffer_store_dwordx4 v[36:39], v1, s[16:19], s46 offen offset:3072 sc0 sc1
    s_sub_u32 s93, s51, s26
    s_and_b32 s93, s93, 3
    s_xor_b32 s29, s51, s25
    s_and_b32 s29, s29, 4
    s_or_b32 s93, s93, s29
    s_lshr_b32 s51, s51, 4
    s_add_u32 s43, s43, 32768
    s_and_b32 s43, s43, 131071
    s_waitcnt vmcnt(0)
    v_add_u32 v252, 1, v250
    s_mov_b32 exec_lo, 0
    s_mov_b32 exec_hi, 65536
    buffer_store_dword v252, v251, s[16:19], 0 offen sc0 sc1
    s_mov_b64 exec, -1
    s_bitcmp1_b32 s92, s93
    s_cbranch_scc1 L_nc_10
    s_mov_b32 s90, 0x40000
    s_lshl_b64 s[88:89], 1, s93
    s_mov_b64 exec, s[88:89]
L_nc_10p:
    buffer_load_dword v252, v251, s[16:19], 0 offen sc0 sc1
    s_waitcnt vmcnt(0)
    v_cmp_ne_u32 vcc, v252, v250
    s_sub_u32 s90, s90, 1
    s_cbranch_scc1 L_nc_10d
    s_or_b32 s92, s92, vcc_lo
    s_mov_b64 exec, s[88:89]
    s_bitcmp1_b32 s92, s93
    s_cbranch_scc1 L_nc_10d
    s_sleep 2
    s_branch L_nc_10p
L_nc_10d:
    s_mov_b64 exec, -1
L_nc_10:
    s_mul_i32 s42, s93, 33536
    s_add_u32 s42, s42, s40
    s_add_u32 m0, s43, 0
    s_add_u32 s29, s42, 0
    buffer_load_dwordx4 v1, s[16:19], s29 offen offset:0 sc1 lds
    buffer_load_dwordx4 v1, s[16:19], s29 offen offset:1024 sc1 lds
    buffer_load_dwordx4 v1, s[16:19], s29 offen offset:2048 sc1 lds
    buffer_load_dwordx4 v1, s[16:19], s29 offen offset:3072 sc1 lds
    s_add_u32 m0, s43, 4096
    s_add_u32 s29, s42, 4096
    buffer_load_dwordx4 v1, s[16:19], s29 offen offset:0 sc1 lds
    buffer_load_dwordx4 v1, s[16:19], s29 offen offset:1024 sc1 lds
    buffer_load_dwordx4 v1, s[16:19], s29 offen offset:2048 sc1 lds
    buffer_load_dwordx4 v1, s[16:19], s29 offen offset:3072 sc1 lds
    s_sub_u32 s93, s51, s26
    s_and_b32 s93, s93, 3
    s_xor_b32 s29, s51, s25
    s_and_b32 s29, s29, 4
    s_or_b32 s93, s93, s29
    s_lshr_b32 s51, s51, 4
    s_add_u32 s43, s43, 32768
    s_and_b32 s43, s43, 131071
    s_waitcnt vmcnt(0)
    s_waitcnt vmcnt(0)
    s_barrier
    s_bitcmp1_b32 s92, s93
    s_cbranch_scc1 L_nc_11
    s_mov_b32 s90, 0x40000
    s_lshl_b64 s[88:89], 1, s93
    s_mov_b64 exec, 0xff
L_nc_11p:
    buffer_load_dword v252, v251, s[16:19], 0 offen sc0 sc1
    s_waitcnt vmcnt(0)
    v_cmp_ne_u32 vcc, v252, v250
    s_sub_u32 s90, s90, 1
    s_cbranch_scc1 L_nc_11d
    s_or_b32 s92, s92, vcc_lo
    s_mov_b64 exec, s[88:89]
    s_bitcmp1_b32 s92, s93
    s_cbranch_scc1 L_nc_11d
    s_sleep 2
    s_branch L_nc_11p
L_nc_11d:
    s_mov_b64 exec, -1
L_nc_11:
    s_mul_i32 s42, s93, 33536
    s_add_u32 s42, s42, s40
    s_add_u32 m0, s43, 0
    s_add_u32 s29, s42, 0
    buffer_load_dwordx4 v1, s[16:19], s29 offen offset:0 sc1 lds
    buffer_load_dwordx4 v1, s[16:19], s29 offen offset:1024 sc1 lds
    buffer_load_dwordx4 v1, s[16:19], s29 offen offset:2048 sc1 lds
    buffer_load_dwordx4 v1, s[16:19], s29 offen offset:3072 sc1 lds
    s_add_u32 m0, s43, 4096
    s_add_u32 s29, s42, 4096
    buffer_load_dwordx4 v1, s[16:19], s29 offen offset:0 sc1 lds
    buffer_load_dwordx4 v1, s[16:19], s29 offen offset:1024 sc1 lds
    buffer_load_dwordx4 v1, s[16:19], s29 offen offset:2048 sc1 lds
    buffer_load_dwordx4 v1, s[16:19], s29 offen offset:3072 sc1 lds
    s_sub_u32 s93, s51, s26
    s_and_b32 s93, s93, 3
    s_xor_b32 s29, s51, s25
    s_and_b32 s29, s29, 4
    s_or_b32 s93, s93, s29
    s_lshr_b32 s51, s51, 4
    s_add_u32 s43, s43, 32768
    s_and_b32 s43, s43, 131071
    s_bitcmp1_b32 s92, s93
    s_cbranch_scc1 L_nc_12
    s_mov_b32 s90, 0x40000
    s_lshl_b64 s[88:89], 1, s93
    s_mov_b64 exec, 0xff
L_nc_12p:
    buffer_load_dword v252, v251, s[16:19], 0 offen sc0 sc1
    s_waitcnt vmcnt(0)
    v_cmp_ne_u32 vcc, v252, v250
    s_sub_u32 s90, s90, 1
    s_cbranch_scc1 L_nc_12d
    s_or_b32 s92, s92, vcc_lo
    s_mov_b64 exec, s[88:89]
    s_bitcmp1_b32 s92, s93
    s_cbranch_scc1 L_nc_12d
    s_sleep 2
    s_branch L_nc_12p
L_nc_12d:
    s_mov_b64 exec, -1
L_nc_12:
    s_mul_i32 s42, s93, 33536
    s_add_u32 s42, s42, s40
    s_add_u32 m0, s43, 0
    s_add_u32 s29, s42, 0
    buffer_load_dwordx4 v1, s[16:19], s29 offen offset:0 sc1 lds
    buffer_load_dwordx4 v1, s[16:19], s29 offen offset:1024 sc1 lds
    buffer_load_dwordx4 v1, s[16:19], s29 offen offset:2048 sc1 lds
    buffer_load_dwordx4 v1, s[16:19], s29 offen offset:3072 sc1 lds
    s_add_u32 m0, s43, 4096
    s_add_u32 s29, s42, 4096
    buffer_load_dwordx4 v1, s[16:19], s29 offen offset:0 sc1 lds
    buffer_load_dwordx4 v1, s[16:19], s29 offen offset:1024 sc1 lds
    buffer_load_dwordx4 v1, s[16:19], s29 offen offset:2048 sc1 lds
    buffer_load_dwordx4 v1, s[16:19], s29 offen offset:3072 sc1 lds
    s_sub_u32 s93, s51, s26
    s_and_b32 s93, s93, 3
    s_xor_b32 s29, s51, s25
    s_and_b32 s29, s29, 4
    s_or_b32 s93, s93, s29
    s_lshr_b32 s51, s51, 4
    s_add_u32 s43, s43, 32768
    s_and_b32 s43, s43, 131071
    buffer_load_dword v96, v247, s[52:55], s50 offen
    s_add_u32 s50, s50, 16384
    s_waitcnt vmcnt(9)
    s_barrier
    s_bitcmp1_b32 s92, s93
    s_cbranch_scc1 L_nc_13
    s_mov_b32 s90, 0x40000
    s_lshl_b64 s[88:89], 1, s93
    s_mov_b64 exec, 0xff
L_nc_13p:
    buffer_load_dword v252, v251, s[16:19], 0 offen sc0 sc1
    s_waitcnt vmcnt(0)
    v_cmp_ne_u32 vcc, v252, v250
    s_sub_u32 s90, s90, 1
    s_cbranch_scc1 L_nc_13d
    s_or_b32 s92, s92, vcc_lo
    s_mov_b64 exec, s[88:89]
    s_bitcmp1_b32 s92, s93
    s_cbranch_scc1 L_nc_13d
    s_sleep 2
    s_branch L_nc_13p
L_nc_13d:
    s_mov_b64 exec, -1
L_nc_13:
    s_mul_i32 s42, s93, 33536
    s_add_u32 s42, s42, s40
    s_add_u32 m0, s43, 0
    s_add_u32 s29, s42, 0
    buffer_load_dwordx4 v1, s[16:19], s29 offen offset:0 sc1 lds
    buffer_load_dwordx4 v1, s[16:19], s29 offen offset:1024 sc1 lds
    buffer_load_dwordx4 v1, s[16:19], s29 offen offset:2048 sc1 lds
    buffer_load_dwordx4 v1, s[16:19], s29 offen offset:3072 sc1 lds
    s_add_u32 m0, s43, 4096
    s_add_u32 s29, s42, 4096
    buffer_load_dwordx4 v1, s[16:19], s29 offen offset:0 sc1 lds
    buffer_load_dwordx4 v1, s[16:19], s29 offen offset:1024 sc1 lds
    buffer_load_dwordx4 v1, s[16:19], s29 offen offset:2048 sc1 lds
    buffer_load_dwordx4 v1, s[16:19], s29 offen offset:3072 sc1 lds
    s_sub_u32 s93, s51, s26
    s_and_b32 s93, s93, 3
    s_xor_b32 s29, s51, s25
    s_and_b32 s29, s29, 4
    s_or_b32 s93, s93, s29
    s_lshr_b32 s51, s51, 4
    s_add_u32 s43, s43, 32768
    s_and_b32 s43, s43, 131071
    s_mov_b32 s88, 65280
    s_mov_b32 s89, 0
    s_mov_b32 s90, 0x40000
    s_mov_b64 exec, s[88:89]
L_pl_14p:
    buffer_load_dword v252, v251, s[16:19], 0 offen sc0 sc1
    s_waitcnt vmcnt(0)
    v_sub_u32 v252, v252, v250
    v_cmp_ne_u32 vcc, 4, v252
    s_sub_u32 s90, s90, 1
    s_cbranch_scc1 L_pl_14d
    s_cbranch_vccz L_pl_14d
    s_sleep 1
    s_branch L_pl_14p
L_pl_14d:
    s_mov_b64 exec, -1
L_pl_14:
    s_lshl_b32 s34, s26, 1
    s_and_b32 s29, s25, 1
    s_add_u32 s34, s34, s29
    s_and_b32 s35, s25, 6
    s_lshl_b32 s35, s35, 3
    s_lshl_b32 s29, s31, 2
    s_add_u32 s35, s35, s29
    s_lshl_b32 s38, s34, 6
    s_add_u32 s38, s38, s35
    s_lshl_b32 s38, s38, 11
    s_add_u32 s38, s38, 12582912
    s_add_u32 s39, s38, 4096
    s_lshl_b32 s46, s35, 5
    s_add_u32 s46, s46, s34
    s_lshl_b32 s46, s46, 11
    s_add_u32 s46, s46, 20971520
    s_lshl_b32 s36, s34, 16
    s_add_u32 s36, s36, 16777216
    s_lshl_b32 s29, s31, 11
    s_add_u32 s36, s36, s29
    buffer_load_dwordx4 v[8:11], v1, s[16:19], s36 offen sc1
    buffer_load_dwordx4 v[12:15], v1, s[16:19], s36 offen offset:1024 sc1
    s_add_u32 s36, s36, 8192
    buffer_load_dwordx4 v[16:19], v1, s[16:19], s36 offen sc1
    buffer_load_dwordx4 v[20:23], v1, s[16:19], s36 offen offset:1024 sc1
    s_add_u32 s36, s36, 8192
    buffer_load_dwordx4 v[24:27], v1, s[16:19], s36 offen sc1
    buffer_load_dwordx4 v[28:31], v1, s[16:19], s36 offen offset:1024 sc1
    s_add_u32 s36, s36, 8192
    buffer_load_dwordx4 v[32:35], v1, s[16:19], s36 offen sc1
    buffer_load_dwordx4 v[36:39], v1, s[16:19], s36 offen offset:1024 sc1
    s_add_u32 s36, s36, 8192
    buffer_load_dwordx4 v[40:43], v1, s[16:19], s36 offen sc1
    buffer_load_dwordx4 v[44:47], v1, s[16:19], s36 offen offset:1024 sc1
    s_add_u32 s36, s36, 8192
    buffer_load_dwordx4 v[48:51], v1, s[16:19], s36 offen sc1
    buffer_load_dwordx4 v[52:55], v1, s[16:19], s36 offen offset:1024 sc1
    s_add_u32 s36, s36, 8192
    buffer_load_dwordx4 v[56:59], v1, s[16:19], s36 offen sc1
    buffer_load_dwordx4 v[60:63], v1, s[16:19], s36 offen offset:1024 sc1
    s_add_u32 s36, s36, 8192
    buffer_load_dwordx4 v[64:67], v1, s[16:19], s36 offen sc1
    buffer_load_dwordx4 v[68:71], v1, s[16:19], s36 offen offset:1024 sc1
    s_and_b32 s37, s31, 1
    s_lshl_b32 s37, s37, 10
    s_lshl_b32 s36, s34, 11
    s_add_u32 s36, s36, s37
    s_add_u32 m0, s37, 136192
    v_lshlrev_b32 v6, 2, v0
    buffer_load_dwordx4 v1, s[20:23], s36 offen lds
    s_lshl_b32 s36, s34, 11
    s_add_u32 s36, s36, 18874368
    buffer_load_dword v88, v6, s[16:19], s36 offen offset:0 sc1
    buffer_load_dword v89, v6, s[16:19], s36 offen offset:256 sc1
    buffer_load_dword v90, v6, s[16:19], s36 offen offset:512 sc1
    buffer_load_dword v91, v6, s[16:19], s36 offen offset:768 sc1
    buffer_load_dword v92, v6, s[16:19], s36 offen offset:1024 sc1
    buffer_load_dword v93, v6, s[16:19], s36 offen offset:1280 sc1
    buffer_load_dword v94, v6, s[16:19], s36 offen offset:1536 sc1
    buffer_load_dword v95, v6, s[16:19], s36 offen offset:1792 sc1
    s_barrier
    s_waitcnt vmcnt(0)
    v_pk_add_f32 v[8:9], v[8:9], v[16:17]
    v_pk_add_f32 v[10:11], v[10:11], v[18:19]
    v_pk_add_f32 v[12:13], v[12:13], v[20:21]
    v_pk_add_f32 v[14:15], v[14:15], v[22:23]
    v_pk_add_f32 v[8:9], v[8:9], v[24:25]
    v_pk_add_f32 v[10:11], v[10:11], v[26:27]
    v_pk_add_f32 v[12:13], v[12:13], v[28:29]
    v_pk_add_f32 v[14:15], v[14:15], v[30:31]
    v_pk_add_f32 v[8:9], v[8:9], v[32:33]
    v_pk_add_f32 v[10:11], v[10:11], v[34:35]
    v_pk_add_f32 v[12:13], v[12:13], v[36:37]
    v_pk_add_f32 v[14:15], v[14:15], v[38:39]
    v_pk_add_f32 v[8:9], v[8:9], v[40:41]
    v_pk_add_f32 v[10:11], v[10:11], v[42:43]
    v_pk_add_f32 v[12:13], v[12:13], v[44:45]
    v_pk_add_f32 v[14:15], v[14:15], v[46:47]
    v_pk_add_f32 v[8:9], v[8:9], v[48:49]
    v_pk_add_f32 v[10:11], v[10:11], v[50:51]
    v_pk_add_f32 v[12:13], v[12:13], v[52:53]
    v_pk_add_f32 v[14:15], v[14:15], v[54:55]
    v_pk_add_f32 v[8:9], v[8:9], v[56:57]
    v_pk_add_f32 v[10:11], v[10:11], v[58:59]
    v_pk_add_f32 v[12:13], v[12:13], v[60:61]
    v_pk_add_f32 v[14:15], v[14:15], v[62:63]
    v_pk_add_f32 v[8:9], v[8:9], v[64:65]
    v_pk_add_f32 v[10:11], v[10:11], v[66:67]
    v_pk_add_f32 v[12:13], v[12:13], v[68:69]
    v_pk_add_f32 v[14:15], v[14:15], v[70:71]
    v_cvt_pk_bf16_f32 v8, v8, v9
    v_cvt_pk_bf16_f32 v9, v10, v11
    v_cvt_pk_bf16_f32 v10, v12, v13
    v_cvt_pk_bf16_f32 v11, v14, v15
    s_lshl_b32 s36, s31, 10
    s_add_u32 s36, s36, 131072
    v_lshrrev_b32 v5, 5, v0
    v_and_b32 v6, 31, v0
    v_lshlrev_b32 v6, 4, v6
    v_lshl_add_u32 v6, v5, 3, v6
    v_add_u32 v6, s36, v6
    ds_write_b64 v6, v[8:9]
    ds_write_b64 v6, v[10:11] offset:512
    v_add_f32 v88, v88, v89
    v_add_f32 v88, v88, v90
    v_add_f32 v88, v88, v91
    v_add_f32 v88, v88, v92
    v_add_f32 v88, v88, v93
    v_add_f32 v88, v88, v94
    v_add_f32 v88, v88, v95
    v_cvt_pk_bf16_f32 v88, v88, v88
    v_lshlrev_b32 v6, 1, v0
    v_add_u32 v6, 135168, v6
    ds_write_b16 v6, v88
    v_mov_b32 v7, 0x3f80
    ds_write_b16 v6, v7 offset:128
    v_mov_b32 v72, 0
    ds_write_b16 v6, v72 offset:256
    v_mov_b32 v73, 0
    v_mov_b32 v74, 0
    v_mov_b32 v75, 0
    v_mov_b32 v76, 0xdddd
    v_bfe_u32 v6, v0, 2, 2
    v_lshl_add_u32 v6, v5, 2, v6
    v_bfe_u32 v7, v0, 4, 1
    v_lshlrev_b32 v4, 5, v7
    v_lshl_add_u32 v6, v6, 6, v4
    v_and_b32 v4, 3, v0
    v_lshl_add_u32 v6, v4, 3, v6
    v_add_u32 v2, 136192, v6
    v_min_u32 v4, 2, v4
    v_lshlrev_b32 v4, 7, v4
    v_lshlrev_b32 v5, 4, v5
    v_lshl_add_u32 v5, v7, 3, v5
    v_add_u32 v5, 135168, v5
    v_and_b32 v6, 4, v0
    v_cmp_eq_u32 vcc, 0, v6
    v_add_u32 v4, v4, v5
    v_add_u32 v5, 256, v5
    v_add_u32 v6, 131072, v1
    v_cndmask_b32 v7, v5, v4, vcc
    v_cndmask_b32 v4, v4, v5, vcc
    buffer_load_dwordx4 v[160:163], v1, s[16:19], s38 offen offset:0 sc1
    buffer_load_dwordx4 v[164:167], v1, s[16:19], s38 offen offset:1024 sc1
    buffer_load_dwordx4 v[168:171], v1, s[16:19], s38 offen offset:2048 sc1
    buffer_load_dwordx4 v[172:175], v1, s[16:19], s38 offen offset:3072 sc1
    buffer_load_dwordx4 v[176:179], v1, s[16:19], s39 offen offset:0 sc1
    buffer_load_dwordx4 v[180:183], v1, s[16:19], s39 offen offset:1024 sc1
    buffer_load_dwordx4 v[184:187], v1, s[16:19], s39 offen offset:2048 sc1
    buffer_load_dwordx4 v[188:191], v1, s[16:19], s39 offen offset:3072 sc1
    s_bitcmp1_b32 s92, s93
    s_cbranch_scc1 L_nc_15
    s_mov_b32 s90, 0x40000
    s_lshl_b64 s[88:89], 1, s93
    s_mov_b64 exec, 0xff
L_nc_15p:
    buffer_load_dword v252, v251, s[16:19], 0 offen sc0 sc1
    s_waitcnt vmcnt(0)
    v_cmp_ne_u32 vcc, v252, v250
    s_sub_u32 s90, s90, 1
    s_cbranch_scc1 L_nc_15d
    s_or_b32 s92, s92, vcc_lo
    s_mov_b64 exec, s[88:89]
    s_bitcmp1_b32 s92, s93
    s_cbranch_scc1 L_nc_15d
    s_sleep 2
    s_branch L_nc_15p
L_nc_15d:
    s_mov_b64 exec, -1
L_nc_15:
    s_mul_i32 s42, s93, 33536
    s_add_u32 s42, s42, s40
    s_add_u32 m0, s43, 0
    s_add_u32 s29, s42, 0
    buffer_load_dwordx4 v1, s[16:19], s29 offen offset:0 sc1 lds
    buffer_load_dwordx4 v1, s[16:19], s29 offen offset:1024 sc1 lds
    buffer_load_dwordx4 v1, s[16:19], s29 offen offset:2048 sc1 lds
    buffer_load_dwordx4 v1, s[16:19], s29 offen offset:3072 sc1 lds
    s_add_u32 m0, s43, 4096
    s_add_u32 s29, s42, 4096
    buffer_load_dwordx4 v1, s[16:19], s29 offen offset:0 sc1 lds
    buffer_load_dwordx4 v1, s[16:19], s29 offen offset:1024 sc1 lds
    buffer_load_dwordx4 v1, s[16:19], s29 offen offset:2048 sc1 lds
    buffer_load_dwordx4 v1, s[16:19], s29 offen offset:3072 sc1 lds
    s_sub_u32 s93, s51, s26
    s_and_b32 s93, s93, 3
    s_xor_b32 s29, s51, s25
    s_and_b32 s29, s29, 4
    s_or_b32 s93, s93, s29
    s_lshr_b32 s51, s51, 4
    s_add_u32 s43, s43, 32768
    s_and_b32 s43, s43, 131071
    s_waitcnt lgkmcnt(0)
    s_barrier
    s_bitcmp1_b32 s92, s93
    s_cbranch_scc1 L_nc_16
    s_mov_b32 s90, 0x40000
    s_lshl_b64 s[88:89], 1, s93
    s_mov_b64 exec, 0xff
L_nc_16p:
    buffer_load_dword v252, v251, s[16:19], 0 offen sc0 sc1
    s_waitcnt vmcnt(0)
    v_cmp_ne_u32 vcc, v252, v250
    s_sub_u32 s90, s90, 1
    s_cbranch_scc1 L_nc_16d
    s_or_b32 s92, s92, vcc_lo
    s_mov_b64 exec, s[88:89]
    s_bitcmp1_b32 s92, s93
    s_cbranch_scc1 L_nc_16d
    s_sleep 2
    s_branch L_nc_16p
L_nc_16d:
    s_mov_b64 exec, -1
L_nc_16:
    s_mul_i32 s42, s93, 33536
    s_add_u32 s42, s42, s40
    s_add_u32 m0, s43, 0
    s_add_u32 s29, s42, 0
    buffer_load_dwordx4 v1, s[16:19], s29 offen offset:0 sc1 lds
    buffer_load_dwordx4 v1, s[16:19], s29 offen offset:1024 sc1 lds
    buffer_load_dwordx4 v1, s[16:19], s29 offen offset:2048 sc1 lds
    buffer_load_dwordx4 v1, s[16:19], s29 offen offset:3072 sc1 lds
    s_add_u32 m0, s43, 4096
    s_add_u32 s29, s42, 4096
    buffer_load_dwordx4 v1, s[16:19], s29 offen offset:0 sc1 lds
    buffer_load_dwordx4 v1, s[16:19], s29 offen offset:1024 sc1 lds
    buffer_load_dwordx4 v1, s[16:19], s29 offen offset:2048 sc1 lds
    buffer_load_dwordx4 v1, s[16:19], s29 offen offset:3072 sc1 lds
    s_sub_u32 s93, s51, s26
    s_and_b32 s93, s93, 3
    s_xor_b32 s29, s51, s25
    s_and_b32 s29, s29, 4
    s_or_b32 s93, s93, s29
    s_lshr_b32 s51, s51, 4
    s_add_u32 s43, s43, 32768
    s_and_b32 s43, s43, 131071
    ds_read_b64_tr_b16 v[8:9], v2 offset:0
    ds_read_b64_tr_b16 v[10:11], v2 offset:1024
    ds_read_b64_tr_b16 v[12:13], v2 offset:512
    ds_read_b64_tr_b16 v[14:15], v2 offset:1536
    ds_read_b128 v[16:19], v6 offset:0
    ds_read_b128 v[20:23], v6 offset:1024
    ds_read_b128 v[24:27], v6 offset:2048
    ds_read_b128 v[28:31], v6 offset:3072
    s_waitcnt lgkmcnt(4)
    ds_read_b64 v[32:33], v7 offset:0
    ds_read_b64 v[34:35], v4 offset:0
    ds_read_b64 v[36:37], v7 offset:32
    ds_read_b64 v[38:39], v4 offset:32
    ds_read_b64 v[40:41], v7 offset:64
    ds_read_b64 v[42:43], v4 offset:64
    ds_read_b64 v[44:45], v7 offset:96
    ds_read_b64 v[46:47], v4 offset:96
    s_waitcnt vmcnt(8) lgkmcnt(0)
    buffer_load_dword v96, v247, s[52:55], s50 offen
    s_add_u32 s50, s50, 16384
    s_mov_b32 s28, 0
L_p2_oa:
    s_cmp_lg_u32 s28, 0
    s_cbranch_scc1 L_p2_q1
    v_mfma_f32_32x32x16_bf16 v[48:63], v[8:11], v[160:163], 0
    v_mfma_f32_32x32x16_bf16 v[48:63], v[12:15], v[164:167], v[48:63]
    s_branch L_p2_qd
L_p2_q1:
    s_cmp_lg_u32 s28, 1
    s_cbranch_scc1 L_p2_q2
    v_mfma_f32_32x32x16_bf16 v[48:63], v[8:11], v[168:171], 0
    v_mfma_f32_32x32x16_bf16 v[48:63], v[12:15], v[172:175], v[48:63]
    s_branch L_p2_qd
L_p2_q2:
    s_cmp_lg_u32 s28, 2
    s_cbranch_scc1 L_p2_q3
    v_mfma_f32_32x32x16_bf16 v[48:63], v[8:11], v[176:179], 0
    v_mfma_f32_32x32x16_bf16 v[48:63], v[12:15], v[180:183], v[48:63]
    s_branch L_p2_qd
L_p2_q3:
    v_mfma_f32_32x32x16_bf16 v[48:63], v[8:11], v[184:187], 0
    v_mfma_f32_32x32x16_bf16 v[48:63], v[12:15], v[188:191], v[48:63]
L_p2_qd:
    v_mfma_f32_32x32x16_bf16 v[136:151], v[72:75], v[72:75], 0
    v_mfma_f32_32x32x16_bf16 v[192:207], v[72:75], v[72:75], 0
    v_mfma_f32_16x16x32_bf16 v[64:67], v[72:75], v[72:75], 0
    v_mfma_f32_16x16x32_bf16 v[68:71], v[72:75], v[72:75], 0
    s_nop 7
    v_max3_f32 v120, v48, v49, v50
    v_min3_f32 v121, v48, v49, v50
    v_max3_f32 v120, v120, v51, v52
    v_min3_f32 v121, v121, v51, v52
    v_max3_f32 v120, v120, v53, v54
    v_min3_f32 v121, v121, v53, v54
    v_max3_f32 v120, v120, v55, v56
    v_min3_f32 v121, v121, v55, v56
    v_max3_f32 v120, v120, v57, v58
    v_min3_f32 v121, v121, v57, v58
    v_max3_f32 v120, v120, v59, v60
    v_min3_f32 v121, v121, v59, v60
    v_max3_f32 v120, v120, v61, v62
    v_min3_f32 v121, v121, v61, v62
    v_max_f32 v120, v120, v63
    v_min_f32 v121, v121, v63
    v_mov_b32 v122, v120
    v_mov_b32 v123, v121
    s_nop 0
    v_permlane32_swap_b32 v120, v122
    v_permlane32_swap_b32 v121, v123
    v_max_f32 v120, v120, v122
    v_min_f32 v121, v121, v123
    v_mul_f32 v124, s44, v120
    v_mul_f32 v126, s44, v121
    v_pk_fma_f32 v[104:105], v[48:49], s[44:45], v[124:125] op_sel_hi:[1,1,0] neg_lo:[0,0,1] neg_hi:[0,0,1]
    v_pk_fma_f32 v[106:107], v[50:51], s[44:45], v[124:125] op_sel_hi:[1,1,0] neg_lo:[0,0,1] neg_hi:[0,0,1]
    v_pk_fma_f32 v[108:109], v[52:53], s[44:45], v[124:125] op_sel_hi:[1,1,0] neg_lo:[0,0,1] neg_hi:[0,0,1]
    v_pk_fma_f32 v[110:111], v[54:55], s[44:45], v[124:125] op_sel_hi:[1,1,0] neg_lo:[0,0,1] neg_hi:[0,0,1]
    v_pk_fma_f32 v[112:113], v[56:57], s[44:45], v[124:125] op_sel_hi:[1,1,0] neg_lo:[0,0,1] neg_hi:[0,0,1]
    v_pk_fma_f32 v[114:115], v[58:59], s[44:45], v[124:125] op_sel_hi:[1,1,0] neg_lo:[0,0,1] neg_hi:[0,0,1]
    v_pk_fma_f32 v[116:117], v[60:61], s[44:45], v[124:125] op_sel_hi:[1,1,0] neg_lo:[0,0,1] neg_hi:[0,0,1]
    v_pk_fma_f32 v[118:119], v[62:63], s[44:45], v[124:125] op_sel_hi:[1,1,0] neg_lo:[0,0,1] neg_hi:[0,0,1]
    v_pk_fma_f32 v[48:49], v[48:49], s[44:45], v[126:127] op_sel_hi:[1,1,0] neg_lo:[1,0,0] neg_hi:[1,0,0]
    v_pk_fma_f32 v[50:51], v[50:51], s[44:45], v[126:127] op_sel_hi:[1,1,0] neg_lo:[1,0,0] neg_hi:[1,0,0]
    v_pk_fma_f32 v[52:53], v[52:53], s[44:45], v[126:127] op_sel_hi:[1,1,0] neg_lo:[1,0,0] neg_hi:[1,0,0]
    v_pk_fma_f32 v[54:55], v[54:55], s[44:45], v[126:127] op_sel_hi:[1,1,0] neg_lo:[1,0,0] neg_hi:[1,0,0]
    v_pk_fma_f32 v[56:57], v[56:57], s[44:45], v[126:127] op_sel_hi:[1,1,0] neg_lo:[1,0,0] neg_hi:[1,0,0]
    v_pk_fma_f32 v[58:59], v[58:59], s[44:45], v[126:127] op_sel_hi:[1,1,0] neg_lo:[1,0,0] neg_hi:[1,0,0]
    v_pk_fma_f32 v[60:61], v[60:61], s[44:45], v[126:127] op_sel_hi:[1,1,0] neg_lo:[1,0,0] neg_hi:[1,0,0]
    v_pk_fma_f32 v[62:63], v[62:63], s[44:45], v[126:127] op_sel_hi:[1,1,0] neg_lo:[1,0,0] neg_hi:[1,0,0]
    v_exp_f32 v104, v104
    v_exp_f32 v105, v105
    v_exp_f32 v106, v106
    v_exp_f32 v107, v107
    v_exp_f32 v108, v108
    v_exp_f32 v109, v109
    v_exp_f32 v110, v110
    v_exp_f32 v111, v111
    v_exp_f32 v112, v112
    v_exp_f32 v113, v113
    v_smfmac_f32_32x32x32_bf16 v[136:151], v[16:19], v[104:111], v76
    v_smfmac_f32_16x16x64_bf16 v[64:67], v[32:35], v[104:111], v76
    v_exp_f32 v114, v114
    v_exp_f32 v115, v115
    v_exp_f32 v116, v116
    v_exp_f32 v117, v117
    v_exp_f32 v118, v118
    v_exp_f32 v119, v119
    v_exp_f32 v48, v48
    v_exp_f32 v49, v49
    v_smfmac_f32_32x32x32_bf16 v[136:151], v[20:23], v[112:119], v76
    v_smfmac_f32_16x16x64_bf16 v[64:67], v[36:39], v[112:119], v76
    v_exp_f32 v50, v50
    v_exp_f32 v51, v51
    v_exp_f32 v52, v52
    v_exp_f32 v53, v53
    v_exp_f32 v54, v54
    v_exp_f32 v55, v55
    v_exp_f32 v56, v56
    v_exp_f32 v57, v57
    v_smfmac_f32_32x32x32_bf16 v[192:207], v[24:27], v[48:55], v76
    v_smfmac_f32_16x16x64_bf16 v[68:71], v[40:43], v[48:55], v76
    v_exp_f32 v58, v58
    v_exp_f32 v59, v59
    v_exp_f32 v60, v60
    v_exp_f32 v61, v61
    v_exp_f32 v62, v62
    v_exp_f32 v63, v63
    s_nop 1
    v_smfmac_f32_32x32x32_bf16 v[192:207], v[28:31], v[56:63], v76
    v_smfmac_f32_16x16x64_bf16 v[68:71], v[44:47], v[56:63], v76
    v_rcp_f32 v65, v65
    s_nop 6
    v_rcp_f32 v69, v69
    v_mov_b32 v120, 897988541
    v_fmac_f32 v120, v64, v65
    v_fmac_f32 v120, v68, v69
    v_rcp_f32 v120, v120
    s_nop 0
    v_mul_f32 v64, v65, v120
    v_mul_f32 v68, v69, v120
    v_pk_mul_f32 v[136:137], v[136:137], v[64:65] op_sel_hi:[1,0]
    v_pk_mul_f32 v[138:139], v[138:139], v[64:65] op_sel_hi:[1,0]
    v_pk_mul_f32 v[140:141], v[140:141], v[64:65] op_sel_hi:[1,0]
    v_pk_mul_f32 v[142:143], v[142:143], v[64:65] op_sel_hi:[1,0]
    v_pk_mul_f32 v[144:145], v[144:145], v[64:65] op_sel_hi:[1,0]
    v_pk_mul_f32 v[146:147], v[146:147], v[64:65] op_sel_hi:[1,0]
    v_pk_mul_f32 v[148:149], v[148:149], v[64:65] op_sel_hi:[1,0]
    v_pk_mul_f32 v[150:151], v[150:151], v[64:65] op_sel_hi:[1,0]
    v_pk_fma_f32 v[136:137], v[192:193], v[68:69], v[136:137] op_sel_hi:[1,0,1]
    v_pk_fma_f32 v[138:139], v[194:195], v[68:69], v[138:139] op_sel_hi:[1,0,1]
    v_pk_fma_f32 v[140:141], v[196:197], v[68:69], v[140:141] op_sel_hi:[1,0,1]
    v_pk_fma_f32 v[142:143], v[198:199], v[68:69], v[142:143] op_sel_hi:[1,0,1]
    v_pk_fma_f32 v[144:145], v[200:201], v[68:69], v[144:145] op_sel_hi:[1,0,1]
    v_pk_fma_f32 v[146:147], v[202:203], v[68:69], v[146:147] op_sel_hi:[1,0,1]
    v_pk_fma_f32 v[148:149], v[204:205], v[68:69], v[148:149] op_sel_hi:[1,0,1]
    v_pk_fma_f32 v[150:151], v[206:207], v[68:69], v[150:151] op_sel_hi:[1,0,1]
    v_cvt_pk_bf16_f32 v208, v136, v137
    v_cvt_pk_bf16_f32 v209, v138, v139
    v_cvt_pk_bf16_f32 v210, v140, v141
    v_cvt_pk_bf16_f32 v211, v142, v143
    v_cvt_pk_bf16_f32 v212, v144, v145
    v_cvt_pk_bf16_f32 v213, v146, v147
    v_cvt_pk_bf16_f32 v214, v148, v149
    v_cvt_pk_bf16_f32 v215, v150, v151
    buffer_store_dwordx4 v[208:211], v1, s[16:19], s46 offen sc0 sc1
    buffer_store_dwordx4 v[212:215], v1, s[16:19], s46 offen offset:1024 sc0 sc1
    s_add_u32 s46, s46, 65536
    s_add_u32 s28, s28, 1
    s_cmp_eq_u32 s28, 2
    s_cbranch_scc0 L_p2_oa1
    s_barrier
    s_bitcmp1_b32 s92, s93
    s_cbranch_scc1 L_nc_17
    s_mov_b32 s90, 0x40000
    s_lshl_b64 s[88:89], 1, s93
    s_mov_b64 exec, 0xff
L_nc_17p:
    buffer_load_dword v252, v251, s[16:19], 0 offen sc0 sc1
    s_waitcnt vmcnt(0)
    v_cmp_ne_u32 vcc, v252, v250
    s_sub_u32 s90, s90, 1
    s_cbranch_scc1 L_nc_17d
    s_or_b32 s92, s92, vcc_lo
    s_mov_b64 exec, s[88:89]
    s_bitcmp1_b32 s92, s93
    s_cbranch_scc1 L_nc_17d
    s_sleep 2
    s_branch L_nc_17p
L_nc_17d:
    s_mov_b64 exec, -1
L_nc_17:
    s_mul_i32 s42, s93, 33536
    s_add_u32 s42, s42, s40
    s_add_u32 m0, s43, 0
    s_add_u32 s29, s42, 0
    buffer_load_dwordx4 v1, s[16:19], s29 offen offset:0 sc1 lds
    buffer_load_dwordx4 v1, s[16:19], s29 offen offset:1024 sc1 lds
    buffer_load_dwordx4 v1, s[16:19], s29 offen offset:2048 sc1 lds
    buffer_load_dwordx4 v1, s[16:19], s29 offen offset:3072 sc1 lds
    s_add_u32 m0, s43, 4096
    s_add_u32 s29, s42, 4096
    buffer_load_dwordx4 v1, s[16:19], s29 offen offset:0 sc1 lds
    buffer_load_dwordx4 v1, s[16:19], s29 offen offset:1024 sc1 lds
    buffer_load_dwordx4 v1, s[16:19], s29 offen offset:2048 sc1 lds
    buffer_load_dwordx4 v1, s[16:19], s29 offen offset:3072 sc1 lds
    s_sub_u32 s93, s51, s26
    s_and_b32 s93, s93, 3
    s_xor_b32 s29, s51, s25
    s_and_b32 s29, s29, 4
    s_or_b32 s93, s93, s29
    s_lshr_b32 s51, s51, 4
    s_add_u32 s43, s43, 32768
    s_and_b32 s43, s43, 131071
L_p2_oa1:
    s_cmp_lt_u32 s28, 4
    s_cbranch_scc1 L_p2_oa
    s_waitcnt vmcnt(12)
    s_setprio 0
L_p2_hjoin:
    s_barrier
    s_cmp_eq_u32 s24, 0
    s_cbranch_scc1 L_p2_nopub
    s_mul_i32 s29, s35, 32
    s_mul_i32 s33, s34, 4
    s_add_u32 s29, s29, s33
    s_add_u32 s29, s29, 30466048
    v_mov_b32 v12, 2
    v_mul_u32_u24 v13, 2048, v0
    s_waitcnt vmcnt(0)
    s_mov_b64 exec, 15
    buffer_atomic_add v12, v13, s[16:19], s29 offen sc1
    s_mov_b64 exec, -1
L_p2_nopub:
    s_mov_b32 s33, s24
    s_mov_b32 s24, s99
    s_and_b32 s25, s3, 3
    s_lshl_b32 s25, s25, 2
    s_bfe_u32 s29, s2, 0x20004
    s_add_u32 s25, s25, s29
    s_and_b32 s26, s3, 4
    s_lshr_b32 s29, s2, 6
    s_add_u32 s26, s26, s29
    s_sub_u32 s36, s27, 4
    v_lshlrev_b32 v1, 4, v0
    v_lshrrev_b32 v2, 4, v0
    v_and_b32 v3, 15, v0
    v_lshlrev_b32 v4, 1, v2
    v_xor_b32 v3, v3, v4
    v_lshlrev_b32 v3, 4, v3
    v_lshl_add_u32 v8, v2, 11, v3
    s_lshl_b32 s29, s26, 8
    s_lshl_b32 s37, s36, 15
    s_add_u32 s29, s29, s37
    v_add_u32 v8, s29, v8
    v_xor_b32 v9, 128, v8
    v_add_u32 v9, 8192, v9
    v_add_u32 v10, 16384, v8
    v_add_u32 v11, 16384, v9
    s_lshl_b32 s38, s25, 2
    s_add_u32 s38, s38, s36
    s_lshl_b32 s38, s38, 16
    s_lshl_b32 s29, s24, 22
    s_add_u32 s38, s38, s29
    s_add_u32 s38, s38, 20971520
    s_lshl_b32 s37, s36, 12
    s_add_u32 s40, s37, 163840
    s_lshr_b32 s42, s3, 1
    s_lshl_b32 s42, s42, 2
    s_add_u32 s42, s42, 4
    s_and_b32 s42, s42, 15
    s_lshr_b32 s43, s25, 1
    s_mov_b32 s44, s42
    s_add_u32 s45, s42, 4
    s_and_b32 s45, s45, 15
    s_add_u32 s46, s42, 8
    s_and_b32 s46, s46, 15
    s_add_u32 s47, s42, 12
    s_and_b32 s47, s47, 15
    s_mov_b32 s30, s37
    s_mov_b32 s48, 0
    s_add_u32 s41, s44, 0
    s_lshl_b32 s39, s41, 17
    s_add_u32 m0, s37, 16384
    s_nop 0
    buffer_load_dwordx4 v8, s[52:55], s39 offen lds
    s_add_u32 m0, s37, 17408
    s_nop 0
    buffer_load_dwordx4 v9, s[52:55], s39 offen lds
    s_add_u32 m0, s37, 18432
    s_nop 0
    buffer_load_dwordx4 v10, s[52:55], s39 offen lds
    s_add_u32 m0, s37, 19456
    s_nop 0
    buffer_load_dwordx4 v11, s[52:55], s39 offen lds
    s_add_u32 s41, s45, 0
    s_lshl_b32 s39, s41, 17
    s_add_u32 m0, s37, 147456
    s_nop 0
    buffer_load_dwordx4 v8, s[52:55], s39 offen lds
    s_add_u32 m0, s37, 148480
    s_nop 0
    buffer_load_dwordx4 v9, s[52:55], s39 offen lds
    s_add_u32 m0, s37, 149504
    s_nop 0
    buffer_load_dwordx4 v10, s[52:55], s39 offen lds
    s_add_u32 m0, s37, 150528
    s_nop 0
    buffer_load_dwordx4 v11, s[52:55], s39 offen lds
    s_waitcnt vmcnt(8)
    s_barrier
    s_add_u32 s41, s44, 1
    s_lshl_b32 s39, s41, 17
    s_add_u32 m0, s37, 49152
    s_nop 0
    buffer_load_dwordx4 v8, s[52:55], s39 offen lds
    s_add_u32 m0, s37, 50176
    s_nop 0
    buffer_load_dwordx4 v9, s[52:55], s39 offen lds
    s_add_u32 m0, s37, 51200
    s_nop 0
    buffer_load_dwordx4 v10, s[52:55], s39 offen lds
    s_add_u32 m0, s37, 52224
    s_nop 0
    buffer_load_dwordx4 v11, s[52:55], s39 offen lds
    s_barrier
    s_mov_b32 exec_lo, 0xffff0000
    s_mov_b32 exec_hi, 0xffff
    buffer_load_dword v252, v251, s[16:19], 0 offen sc0 sc1
    s_waitcnt vmcnt(0)
    v_sub_u32 v252, v252, v250
    v_cmp_eq_u32 vcc, 2, v252
    s_mov_b64 exec, -1
    s_lshr_b64 s[88:89], vcc, 16
    s_mov_b32 s92, s88
    s_mov_b32 s93, 0
    s_add_u32 s41, s44, 0
    s_lshl_b32 s29, s41, 1
    s_lshl_b32 s29, 3, s29
    s_or_b32 s93, s93, s29
    s_add_u32 s41, s44, 1
    s_lshl_b32 s29, s41, 1
    s_lshl_b32 s29, 3, s29
    s_or_b32 s93, s93, s29
    s_add_u32 s41, s44, 2
    s_lshl_b32 s29, s41, 1
    s_lshl_b32 s29, 3, s29
    s_or_b32 s93, s93, s29
    s_andn2_b32 s88, s93, s92
    s_cbranch_scc1 L_p3_notyet
    s_cmp_eq_u32 s24, 0
    s_cbranch_scc1 L_p3_notyet
    s_mov_b32 s48, 1
    s_add_u32 s41, s44, 0
    s_add_u32 m0, s37, 0
    s_lshl_b32 s29, s41, 12
    s_add_u32 s29, s29, s38
    buffer_load_dwordx4 v1, s[16:19], s29 offen offset:0 sc1 lds
    buffer_load_dwordx4 v1, s[16:19], s29 offen offset:1024 sc1 lds
    buffer_load_dwordx4 v1, s[16:19], s29 offen offset:2048 sc1 lds
    buffer_load_dwordx4 v1, s[16:19], s29 offen offset:3072 sc1 lds
    s_add_u32 s41, s44, 1
    s_add_u32 m0, s37, 32768
    s_lshl_b32 s29, s41, 12
    s_add_u32 s29, s29, s38
    buffer_load_dwordx4 v1, s[16:19], s29 offen offset:0 sc1 lds
    buffer_load_dwordx4 v1, s[16:19], s29 offen offset:1024 sc1 lds
    buffer_load_dwordx4 v1, s[16:19], s29 offen offset:2048 sc1 lds
    buffer_load_dwordx4 v1, s[16:19], s29 offen offset:3072 sc1 lds
    s_add_u32 s41, s44, 2
    s_add_u32 m0, s37, 65536
    s_lshl_b32 s29, s41, 12
    s_add_u32 s29, s29, s38
    buffer_load_dwordx4 v1, s[16:19], s29 offen offset:0 sc1 lds
    buffer_load_dwordx4 v1, s[16:19], s29 offen offset:1024 sc1 lds
    buffer_load_dwordx4 v1, s[16:19], s29 offen offset:2048 sc1 lds
    buffer_load_dwordx4 v1, s[16:19], s29 offen offset:3072 sc1 lds
L_p3_notyet:
    s_barrier
    s_add_u32 s41, s44, 2
    s_lshl_b32 s39, s41, 17
    s_add_u32 m0, s37, 81920
    s_nop 0
    buffer_load_dwordx4 v8, s[52:55], s39 offen lds
    s_add_u32 m0, s37, 82944
    s_nop 0
    buffer_load_dwordx4 v9, s[52:55], s39 offen lds
    s_add_u32 m0, s37, 83968
    s_nop 0
    buffer_load_dwordx4 v10, s[52:55], s39 offen lds
    s_add_u32 m0, s37, 84992
    s_nop 0
    buffer_load_dwordx4 v11, s[52:55], s39 offen lds
    s_add_u32 s41, s44, 3
    s_lshl_b32 s39, s41, 17
    s_add_u32 m0, s37, 114688
    s_nop 0
    buffer_load_dwordx4 v8, s[52:55], s39 offen lds
    s_add_u32 m0, s37, 115712
    s_nop 0
    buffer_load_dwordx4 v9, s[52:55], s39 offen lds
    s_add_u32 m0, s37, 116736
    s_nop 0
    buffer_load_dwordx4 v10, s[52:55], s39 offen lds
    s_add_u32 m0, s37, 117760
    s_nop 0
    buffer_load_dwordx4 v11, s[52:55], s39 offen lds
    s_cmp_lg_u32 s48, 0
    s_cbranch_scc1 L_p3_have
    s_mov_b32 s90, 0x40000
L_nm_18p:
    s_andn2_b32 s88, s93, s92
    s_cbranch_scc0 L_nm_18
    s_sub_u32 s90, s90, 1
    s_cbranch_scc1 L_nm_18
    s_mov_b32 exec_lo, 0xffff0000
    s_mov_b32 exec_hi, 0xffff
    buffer_load_dword v252, v251, s[16:19], 0 offen sc0 sc1
    s_waitcnt vmcnt(0)
    v_sub_u32 v252, v252, v250
    v_cmp_eq_u32 vcc, 2, v252
    s_mov_b64 exec, -1
    s_lshr_b64 s[88:89], vcc, 16
    s_mov_b32 s92, s88
    s_branch L_nm_18p
L_nm_18:
    s_add_u32 s41, s44, 0
    s_add_u32 m0, s37, 0
    s_lshl_b32 s29, s41, 12
    s_add_u32 s29, s29, s38
    buffer_load_dwordx4 v1, s[16:19], s29 offen offset:0 sc1 lds
    buffer_load_dwordx4 v1, s[16:19], s29 offen offset:1024 sc1 lds
    buffer_load_dwordx4 v1, s[16:19], s29 offen offset:2048 sc1 lds
    buffer_load_dwordx4 v1, s[16:19], s29 offen offset:3072 sc1 lds
    s_add_u32 s41, s44, 1
    s_add_u32 m0, s37, 32768
    s_lshl_b32 s29, s41, 12
    s_add_u32 s29, s29, s38
    buffer_load_dwordx4 v1, s[16:19], s29 offen offset:0 sc1 lds
    buffer_load_dwordx4 v1, s[16:19], s29 offen offset:1024 sc1 lds
    buffer_load_dwordx4 v1, s[16:19], s29 offen offset:2048 sc1 lds
    buffer_load_dwordx4 v1, s[16:19], s29 offen offset:3072 sc1 lds
    s_add_u32 s41, s44, 2
    s_add_u32 m0, s37, 65536
    s_lshl_b32 s29, s41, 12
    s_add_u32 s29, s29, s38
    buffer_load_dwordx4 v1, s[16:19], s29 offen offset:0 sc1 lds
    buffer_load_dwordx4 v1, s[16:19], s29 offen offset:1024 sc1 lds
    buffer_load_dwordx4 v1, s[16:19], s29 offen offset:2048 sc1 lds
    buffer_load_dwordx4 v1, s[16:19], s29 offen offset:3072 sc1 lds
L_p3_have:
    s_waitcnt vmcnt(8)
    s_barrier
    s_mov_b32 s93, 0
    s_add_u32 s41, s44, 3
    s_lshl_b32 s29, s41, 1
    s_lshl_b32 s29, 3, s29
    s_or_b32 s93, s93, s29
    s_mov_b32 s90, 0x40000
L_nm_19p:
    s_andn2_b32 s88, s93, s92
    s_cbranch_scc0 L_nm_19
    s_sub_u32 s90, s90, 1
    s_cbranch_scc1 L_nm_19
    s_mov_b32 exec_lo, 0xffff0000
    s_mov_b32 exec_hi, 0xffff
    buffer_load_dword v252, v251, s[16:19], 0 offen sc0 sc1
    s_waitcnt vmcnt(0)
    v_sub_u32 v252, v252, v250
    v_cmp_eq_u32 vcc, 2, v252
    s_mov_b64 exec, -1
    s_lshr_b64 s[88:89], vcc, 16
    s_mov_b32 s92, s88
    s_branch L_nm_19p
L_nm_19:
    s_add_u32 s41, s44, 3
    s_add_u32 m0, s37, 98304
    s_lshl_b32 s29, s41, 12
    s_add_u32 s29, s29, s38
    buffer_load_dwordx4 v1, s[16:19], s29 offen offset:0 sc1 lds
    buffer_load_dwordx4 v1, s[16:19], s29 offen offset:1024 sc1 lds
    buffer_load_dwordx4 v1, s[16:19], s29 offen offset:2048 sc1 lds
    buffer_load_dwordx4 v1, s[16:19], s29 offen offset:3072 sc1 lds
    s_waitcnt vmcnt(8)
    s_barrier
    s_mov_b32 s93, 0
    s_add_u32 s41, s45, 0
    s_lshl_b32 s29, s41, 1
    s_lshl_b32 s29, 3, s29
    s_or_b32 s93, s93, s29
    s_mov_b32 s90, 0x40000
L_nm_20p:
    s_andn2_b32 s88, s93, s92
    s_cbranch_scc0 L_nm_20
    s_sub_u32 s90, s90, 1
    s_cbranch_scc1 L_nm_20
    s_mov_b32 exec_lo, 0xffff0000
    s_mov_b32 exec_hi, 0xffff
    buffer_load_dword v252, v251, s[16:19], 0 offen sc0 sc1
    s_waitcnt vmcnt(0)
    v_sub_u32 v252, v252, v250
    v_cmp_eq_u32 vcc, 2, v252
    s_mov_b64 exec, -1
    s_lshr_b64 s[88:89], vcc, 16
    s_mov_b32 s92, s88
    s_branch L_nm_20p
L_nm_20:
    s_add_u32 s41, s45, 0
    s_add_u32 m0, s37, 131072
    s_lshl_b32 s29, s41, 12
    s_add_u32 s29, s29, s38
    buffer_load_dwordx4 v1, s[16:19], s29 offen offset:0 sc1 lds
    buffer_load_dwordx4 v1, s[16:19], s29 offen offset:1024 sc1 lds
    buffer_load_dwordx4 v1, s[16:19], s29 offen offset:2048 sc1 lds
    buffer_load_dwordx4 v1, s[16:19], s29 offen offset:3072 sc1 lds
    v_add_u32 v12, s37, v1
    s_waitcnt vmcnt(8) lgkmcnt(0)
    s_barrier
    s_add_u32 s41, s45, 1
    s_lshl_b32 s39, s41, 17
    s_add_u32 m0, s37, 16384
    s_nop 0
    buffer_load_dwordx4 v8, s[52:55], s39 offen lds
    s_add_u32 m0, s37, 17408
    s_nop 0
    buffer_load_dwordx4 v9, s[52:55], s39 offen lds
    s_add_u32 m0, s37, 18432
    s_nop 0
    buffer_load_dwordx4 v10, s[52:55], s39 offen lds
    s_add_u32 m0, s37, 19456
    s_nop 0
    buffer_load_dwordx4 v11, s[52:55], s39 offen lds
    s_mov_b32 s93, 0
    s_add_u32 s41, s45, 1
    s_lshl_b32 s29, s41, 1
    s_lshl_b32 s29, 3, s29
    s_or_b32 s93, s93, s29
    s_mov_b32 s90, 0x40000
L_nm_21p:
    s_andn2_b32 s88, s93, s92
    s_cbranch_scc0 L_nm_21
    s_sub_u32 s90, s90, 1
    s_cbranch_scc1 L_nm_21
    s_mov_b32 exec_lo, 0xffff0000
    s_mov_b32 exec_hi, 0xffff
    buffer_load_dword v252, v251, s[16:19], 0 offen sc0 sc1
    s_waitcnt vmcnt(0)
    v_sub_u32 v252, v252, v250
    v_cmp_eq_u32 vcc, 2, v252
    s_mov_b64 exec, -1
    s_lshr_b64 s[88:89], vcc, 16
    s_mov_b32 s92, s88
    s_branch L_nm_21p
L_nm_21:
    s_add_u32 m0, s37, 0
    s_lshl_b32 s29, s41, 12
    s_add_u32 s29, s29, s38
    buffer_load_dwordx4 v1, s[16:19], s29 offen offset:0 sc1 lds
    buffer_load_dwordx4 v1, s[16:19], s29 offen offset:1024 sc1 lds
    buffer_load_dwordx4 v1, s[16:19], s29 offen offset:2048 sc1 lds
    buffer_load_dwordx4 v1, s[16:19], s29 offen offset:3072 sc1 lds
    s_waitcnt vmcnt(12) lgkmcnt(0)
    s_barrier
    s_add_u32 s41, s45, 2
    s_lshl_b32 s39, s41, 17
    s_add_u32 m0, s37, 49152
    s_nop 0
    buffer_load_dwordx4 v8, s[52:55], s39 offen lds
    s_add_u32 m0, s37, 50176
    s_nop 0
    buffer_load_dwordx4 v9, s[52:55], s39 offen lds
    s_add_u32 m0, s37, 51200
    s_nop 0
    buffer_load_dwordx4 v10, s[52:55], s39 offen lds
    s_add_u32 m0, s37, 52224
    s_nop 0
    buffer_load_dwordx4 v11, s[52:55], s39 offen lds
    s_mov_b32 s93, 0
    s_add_u32 s41, s45, 2
    s_lshl_b32 s29, s41, 1
    s_lshl_b32 s29, 3, s29
    s_or_b32 s93, s93, s29
    s_mov_b32 s90, 0x40000
L_nm_22p:
    s_andn2_b32 s88, s93, s92
    s_cbranch_scc0 L_nm_22
    s_sub_u32 s90, s90, 1
    s_cbranch_scc1 L_nm_22
    s_mov_b32 exec_lo, 0xffff0000
    s_mov_b32 exec_hi, 0xffff
    buffer_load_dword v252, v251, s[16:19], 0 offen sc0 sc1
    s_waitcnt vmcnt(0)
    v_sub_u32 v252, v252, v250
    v_cmp_eq_u32 vcc, 2, v252
    s_mov_b64 exec, -1
    s_lshr_b64 s[88:89], vcc, 16
    s_mov_b32 s92, s88
    s_branch L_nm_22p
L_nm_22:
    s_add_u32 m0, s37, 32768
    s_lshl_b32 s29, s41, 12
    s_add_u32 s29, s29, s38
    buffer_load_dwordx4 v1, s[16:19], s29 offen offset:0 sc1 lds
    buffer_load_dwordx4 v1, s[16:19], s29 offen offset:1024 sc1 lds
    buffer_load_dwordx4 v1, s[16:19], s29 offen offset:2048 sc1 lds
    buffer_load_dwordx4 v1, s[16:19], s29 offen offset:3072 sc1 lds
    s_waitcnt vmcnt(16) lgkmcnt(0)
    s_barrier
    s_add_u32 s41, s45, 3
    s_lshl_b32 s39, s41, 17
    s_add_u32 m0, s37, 81920
    s_nop 0
    buffer_load_dwordx4 v8, s[52:55], s39 offen lds
    s_add_u32 m0, s37, 82944
    s_nop 0
    buffer_load_dwordx4 v9, s[52:55], s39 offen lds
    s_add_u32 m0, s37, 83968
    s_nop 0
    buffer_load_dwordx4 v10, s[52:55], s39 offen lds
    s_add_u32 m0, s37, 84992
    s_nop 0
    buffer_load_dwordx4 v11, s[52:55], s39 offen lds
    s_mov_b32 s93, 0
    s_add_u32 s41, s45, 3
    s_lshl_b32 s29, s41, 1
    s_lshl_b32 s29, 3, s29
    s_or_b32 s93, s93, s29
    s_mov_b32 s90, 0x40000
L_nm_23p:
    s_andn2_b32 s88, s93, s92
    s_cbranch_scc0 L_nm_23
    s_sub_u32 s90, s90, 1
    s_cbranch_scc1 L_nm_23
    s_mov_b32 exec_lo, 0xffff0000
    s_mov_b32 exec_hi, 0xffff
    buffer_load_dword v252, v251, s[16:19], 0 offen sc0 sc1
    s_waitcnt vmcnt(0)
    v_sub_u32 v252, v252, v250
    v_cmp_eq_u32 vcc, 2, v252
    s_mov_b64 exec, -1
    s_lshr_b64 s[88:89], vcc, 16
    s_mov_b32 s92, s88
    s_branch L_nm_23p
L_nm_23:
    s_add_u32 m0, s37, 65536
    s_lshl_b32 s29, s41, 12
    s_add_u32 s29, s29, s38
    buffer_load_dwordx4 v1, s[16:19], s29 offen offset:0 sc1 lds
    buffer_load_dwordx4 v1, s[16:19], s29 offen offset:1024 sc1 lds
    buffer_load_dwordx4 v1, s[16:19], s29 offen offset:2048 sc1 lds
    buffer_load_dwordx4 v1, s[16:19], s29 offen offset:3072 sc1 lds
    s_waitcnt vmcnt(16) lgkmcnt(0)
    s_barrier
    s_add_u32 s41, s46, 0
    s_lshl_b32 s39, s41, 17
    s_add_u32 m0, s37, 114688
    s_nop 0
    buffer_load_dwordx4 v8, s[52:55], s39 offen lds
    s_add_u32 m0, s37, 115712
    s_nop 0
    buffer_load_dwordx4 v9, s[52:55], s39 offen lds
    s_add_u32 m0, s37, 116736
    s_nop 0
    buffer_load_dwordx4 v10, s[52:55], s39 offen lds
    s_add_u32 m0, s37, 117760
    s_nop 0
    buffer_load_dwordx4 v11, s[52:55], s39 offen lds
    s_mov_b32 s93, 0
    s_add_u32 s41, s46, 0
    s_lshl_b32 s29, s41, 1
    s_lshl_b32 s29, 3, s29
    s_or_b32 s93, s93, s29
    s_mov_b32 s90, 0x40000
L_nm_24p:
    s_andn2_b32 s88, s93, s92
    s_cbranch_scc0 L_nm_24
    s_sub_u32 s90, s90, 1
    s_cbranch_scc1 L_nm_24
    s_mov_b32 exec_lo, 0xffff0000
    s_mov_b32 exec_hi, 0xffff
    buffer_load_dword v252, v251, s[16:19], 0 offen sc0 sc1
    s_waitcnt vmcnt(0)
    v_sub_u32 v252, v252, v250
    v_cmp_eq_u32 vcc, 2, v252
    s_mov_b64 exec, -1
    s_lshr_b64 s[88:89], vcc, 16
    s_mov_b32 s92, s88
    s_branch L_nm_24p
L_nm_24:
    s_add_u32 m0, s37, 98304
    s_lshl_b32 s29, s41, 12
    s_add_u32 s29, s29, s38
    buffer_load_dwordx4 v1, s[16:19], s29 offen offset:0 sc1 lds
    buffer_load_dwordx4 v1, s[16:19], s29 offen offset:1024 sc1 lds
    buffer_load_dwordx4 v1, s[16:19], s29 offen offset:2048 sc1 lds
    buffer_load_dwordx4 v1, s[16:19], s29 offen offset:3072 sc1 lds
    s_waitcnt vmcnt(16) lgkmcnt(0)
    s_barrier
    s_add_u32 s41, s46, 1
    s_lshl_b32 s39, s41, 17
    s_add_u32 m0, s37, 147456
    s_nop 0
    buffer_load_dwordx4 v8, s[52:55], s39 offen lds
    s_add_u32 m0, s37, 148480
    s_nop 0
    buffer_load_dwordx4 v9, s[52:55], s39 offen lds
    s_add_u32 m0, s37, 149504
    s_nop 0
    buffer_load_dwordx4 v10, s[52:55], s39 offen lds
    s_add_u32 m0, s37, 150528
    s_nop 0
    buffer_load_dwordx4 v11, s[52:55], s39 offen lds
    s_mov_b32 s93, 0
    s_add_u32 s41, s46, 1
    s_lshl_b32 s29, s41, 1
    s_lshl_b32 s29, 3, s29
    s_or_b32 s93, s93, s29
    s_mov_b32 s90, 0x40000
L_nm_25p:
    s_andn2_b32 s88, s93, s92
    s_cbranch_scc0 L_nm_25
    s_sub_u32 s90, s90, 1
    s_cbranch_scc1 L_nm_25
    s_mov_b32 exec_lo, 0xffff0000
    s_mov_b32 exec_hi, 0xffff
    buffer_load_dword v252, v251, s[16:19], 0 offen sc0 sc1
    s_waitcnt vmcnt(0)
    v_sub_u32 v252, v252, v250
    v_cmp_eq_u32 vcc, 2, v252
    s_mov_b64 exec, -1
    s_lshr_b64 s[88:89], vcc, 16
    s_mov_b32 s92, s88
    s_branch L_nm_25p
L_nm_25:
    s_add_u32 m0, s37, 131072
    s_lshl_b32 s29, s41, 12
    s_add_u32 s29, s29, s38
    buffer_load_dwordx4 v1, s[16:19], s29 offen offset:0 sc1 lds
    buffer_load_dwordx4 v1, s[16:19], s29 offen offset:1024 sc1 lds
    buffer_load_dwordx4 v1, s[16:19], s29 offen offset:2048 sc1 lds
    buffer_load_dwordx4 v1, s[16:19], s29 offen offset:3072 sc1 lds
    s_waitcnt vmcnt(16) lgkmcnt(0)
    s_barrier
    s_add_u32 s41, s46, 2
    s_lshl_b32 s39, s41, 17
    s_add_u32 m0, s37, 16384
    s_nop 0
    buffer_load_dwordx4 v8, s[52:55], s39 offen lds
    s_add_u32 m0, s37, 17408
    s_nop 0
    buffer_load_dwordx4 v9, s[52:55], s39 offen lds
    s_add_u32 m0, s37, 18432
    s_nop 0
    buffer_load_dwordx4 v10, s[52:55], s39 offen lds
    s_add_u32 m0, s37, 19456
    s_nop 0
    buffer_load_dwordx4 v11, s[52:55], s39 offen lds
    s_mov_b32 s93, 0
    s_add_u32 s41, s46, 2
    s_lshl_b32 s29, s41, 1
    s_lshl_b32 s29, 3, s29
    s_or_b32 s93, s93, s29
    s_mov_b32 s90, 0x40000
L_nm_26p:
    s_andn2_b32 s88, s93, s92
    s_cbranch_scc0 L_nm_26
    s_sub_u32 s90, s90, 1
    s_cbranch_scc1 L_nm_26
    s_mov_b32 exec_lo, 0xffff0000
    s_mov_b32 exec_hi, 0xffff
    buffer_load_dword v252, v251, s[16:19], 0 offen sc0 sc1
    s_waitcnt vmcnt(0)
    v_sub_u32 v252, v252, v250
    v_cmp_eq_u32 vcc, 2, v252
    s_mov_b64 exec, -1
    s_lshr_b64 s[88:89], vcc, 16
    s_mov_b32 s92, s88
    s_branch L_nm_26p
L_nm_26:
    s_add_u32 m0, s37, 0
    s_lshl_b32 s29, s41, 12
    s_add_u32 s29, s29, s38
    buffer_load_dwordx4 v1, s[16:19], s29 offen offset:0 sc1 lds
    buffer_load_dwordx4 v1, s[16:19], s29 offen offset:1024 sc1 lds
    buffer_load_dwordx4 v1, s[16:19], s29 offen offset:2048 sc1 lds
    buffer_load_dwordx4 v1, s[16:19], s29 offen offset:3072 sc1 lds
    s_waitcnt vmcnt(16) lgkmcnt(0)
    s_barrier
    s_add_u32 s41, s46, 3
    s_lshl_b32 s39, s41, 17
    s_add_u32 m0, s37, 49152
    s_nop 0
    buffer_load_dwordx4 v8, s[52:55], s39 offen lds
    s_add_u32 m0, s37, 50176
    s_nop 0
    buffer_load_dwordx4 v9, s[52:55], s39 offen lds
    s_add_u32 m0, s37, 51200
    s_nop 0
    buffer_load_dwordx4 v10, s[52:55], s39 offen lds
    s_add_u32 m0, s37, 52224
    s_nop 0
    buffer_load_dwordx4 v11, s[52:55], s39 offen lds
    s_mov_b32 s93, 0
    s_add_u32 s41, s46, 3
    s_lshl_b32 s29, s41, 1
    s_lshl_b32 s29, 3, s29
    s_or_b32 s93, s93, s29
    s_mov_b32 s90, 0x40000
L_nm_27p:
    s_andn2_b32 s88, s93, s92
    s_cbranch_scc0 L_nm_27
    s_sub_u32 s90, s90, 1
    s_cbranch_scc1 L_nm_27
    s_mov_b32 exec_lo, 0xffff0000
    s_mov_b32 exec_hi, 0xffff
    buffer_load_dword v252, v251, s[16:19], 0 offen sc0 sc1
    s_waitcnt vmcnt(0)
    v_sub_u32 v252, v252, v250
    v_cmp_eq_u32 vcc, 2, v252
    s_mov_b64 exec, -1
    s_lshr_b64 s[88:89], vcc, 16
    s_mov_b32 s92, s88
    s_branch L_nm_27p
L_nm_27:
    s_add_u32 m0, s37, 32768
    s_lshl_b32 s29, s41, 12
    s_add_u32 s29, s29, s38
    buffer_load_dwordx4 v1, s[16:19], s29 offen offset:0 sc1 lds
    buffer_load_dwordx4 v1, s[16:19], s29 offen offset:1024 sc1 lds
    buffer_load_dwordx4 v1, s[16:19], s29 offen offset:2048 sc1 lds
    buffer_load_dwordx4 v1, s[16:19], s29 offen offset:3072 sc1 lds
    s_waitcnt vmcnt(16) lgkmcnt(0)
    s_barrier
    s_add_u32 s41, s47, 0
    s_lshl_b32 s39, s41, 17
    s_add_u32 m0, s37, 81920
    s_nop 0
    buffer_load_dwordx4 v8, s[52:55], s39 offen lds
    s_add_u32 m0, s37, 82944
    s_nop 0
    buffer_load_dwordx4 v9, s[52:55], s39 offen lds
    s_add_u32 m0, s37, 83968
    s_nop 0
    buffer_load_dwordx4 v10, s[52:55], s39 offen lds
    s_add_u32 m0, s37, 84992
    s_nop 0
    buffer_load_dwordx4 v11, s[52:55], s39 offen lds
    s_mov_b32 s93, 0
    s_add_u32 s41, s47, 0
    s_lshl_b32 s29, s41, 1
    s_lshl_b32 s29, 3, s29
    s_or_b32 s93, s93, s29
    s_mov_b32 s90, 0x40000
L_nm_28p:
    s_andn2_b32 s88, s93, s92
    s_cbranch_scc0 L_nm_28
    s_sub_u32 s90, s90, 1
    s_cbranch_scc1 L_nm_28
    s_mov_b32 exec_lo, 0xffff0000
    s_mov_b32 exec_hi, 0xffff
    buffer_load_dword v252, v251, s[16:19], 0 offen sc0 sc1
    s_waitcnt vmcnt(0)
    v_sub_u32 v252, v252, v250
    v_cmp_eq_u32 vcc, 2, v252
    s_mov_b64 exec, -1
    s_lshr_b64 s[88:89], vcc, 16
    s_mov_b32 s92, s88
    s_branch L_nm_28p
L_nm_28:
    s_add_u32 m0, s37, 65536
    s_lshl_b32 s29, s41, 12
    s_add_u32 s29, s29, s38
    buffer_load_dwordx4 v1, s[16:19], s29 offen offset:0 sc1 lds
    buffer_load_dwordx4 v1, s[16:19], s29 offen offset:1024 sc1 lds
    buffer_load_dwordx4 v1, s[16:19], s29 offen offset:2048 sc1 lds
    buffer_load_dwordx4 v1, s[16:19], s29 offen offset:3072 sc1 lds
    s_waitcnt vmcnt(16) lgkmcnt(0)
    s_barrier
    s_add_u32 s41, s47, 1
    s_lshl_b32 s39, s41, 17
    s_add_u32 m0, s37, 114688
    s_nop 0
    buffer_load_dwordx4 v8, s[52:55], s39 offen lds
    s_add_u32 m0, s37, 115712
    s_nop 0
    buffer_load_dwordx4 v9, s[52:55], s39 offen lds
    s_add_u32 m0, s37, 116736
    s_nop 0
    buffer_load_dwordx4 v10, s[52:55], s39 offen lds
    s_add_u32 m0, s37, 117760
    s_nop 0
    buffer_load_dwordx4 v11, s[52:55], s39 offen lds
    s_mov_b32 s93, 0
    s_add_u32 s41, s47, 1
    s_lshl_b32 s29, s41, 1
    s_lshl_b32 s29, 3, s29
    s_or_b32 s93, s93, s29
    s_mov_b32 s90, 0x40000
L_nm_29p:
    s_andn2_b32 s88, s93, s92
    s_cbranch_scc0 L_nm_29
    s_sub_u32 s90, s90, 1
    s_cbranch_scc1 L_nm_29
    s_mov_b32 exec_lo, 0xffff0000
    s_mov_b32 exec_hi, 0xffff
    buffer_load_dword v252, v251, s[16:19], 0 offen sc0 sc1
    s_waitcnt vmcnt(0)
    v_sub_u32 v252, v252, v250
    v_cmp_eq_u32 vcc, 2, v252
    s_mov_b64 exec, -1
    s_lshr_b64 s[88:89], vcc, 16
    s_mov_b32 s92, s88
    s_branch L_nm_29p
L_nm_29:
    s_add_u32 m0, s37, 98304
    s_lshl_b32 s29, s41, 12
    s_add_u32 s29, s29, s38
    buffer_load_dwordx4 v1, s[16:19], s29 offen offset:0 sc1 lds
    buffer_load_dwordx4 v1, s[16:19], s29 offen offset:1024 sc1 lds
    buffer_load_dwordx4 v1, s[16:19], s29 offen offset:2048 sc1 lds
    buffer_load_dwordx4 v1, s[16:19], s29 offen offset:3072 sc1 lds
    s_waitcnt vmcnt(16) lgkmcnt(0)
    s_barrier
    s_add_u32 s41, s47, 2
    s_lshl_b32 s39, s41, 17
    s_add_u32 m0, s37, 147456
    s_nop 0
    buffer_load_dwordx4 v8, s[52:55], s39 offen lds
    s_add_u32 m0, s37, 148480
    s_nop 0
    buffer_load_dwordx4 v9, s[52:55], s39 offen lds
    s_add_u32 m0, s37, 149504
    s_nop 0
    buffer_load_dwordx4 v10, s[52:55], s39 offen lds
    s_add_u32 m0, s37, 150528
    s_nop 0
    buffer_load_dwordx4 v11, s[52:55], s39 offen lds
    s_mov_b32 s93, 0
    s_add_u32 s41, s47, 2
    s_lshl_b32 s29, s41, 1
    s_lshl_b32 s29, 3, s29
    s_or_b32 s93, s93, s29
    s_mov_b32 s90, 0x40000
L_nm_30p:
    s_andn2_b32 s88, s93, s92
    s_cbranch_scc0 L_nm_30
    s_sub_u32 s90, s90, 1
    s_cbranch_scc1 L_nm_30
    s_mov_b32 exec_lo, 0xffff0000
    s_mov_b32 exec_hi, 0xffff
    buffer_load_dword v252, v251, s[16:19], 0 offen sc0 sc1
    s_waitcnt vmcnt(0)
    v_sub_u32 v252, v252, v250
    v_cmp_eq_u32 vcc, 2, v252
    s_mov_b64 exec, -1
    s_lshr_b64 s[88:89], vcc, 16
    s_mov_b32 s92, s88
    s_branch L_nm_30p
L_nm_30:
    s_add_u32 m0, s37, 131072
    s_lshl_b32 s29, s41, 12
    s_add_u32 s29, s29, s38
    buffer_load_dwordx4 v1, s[16:19], s29 offen offset:0 sc1 lds
    buffer_load_dwordx4 v1, s[16:19], s29 offen offset:1024 sc1 lds
    buffer_load_dwordx4 v1, s[16:19], s29 offen offset:2048 sc1 lds
    buffer_load_dwordx4 v1, s[16:19], s29 offen offset:3072 sc1 lds
    s_waitcnt vmcnt(16) lgkmcnt(0)
    s_barrier
    s_add_u32 s41, s47, 3
    s_lshl_b32 s39, s41, 17
    s_add_u32 m0, s37, 16384
    s_nop 0
    buffer_load_dwordx4 v8, s[52:55], s39 offen lds
    s_add_u32 m0, s37, 17408
    s_nop 0
    buffer_load_dwordx4 v9, s[52:55], s39 offen lds
    s_add_u32 m0, s37, 18432
    s_nop 0
    buffer_load_dwordx4 v10, s[52:55], s39 offen lds
    s_add_u32 m0, s37, 19456
    s_nop 0
    buffer_load_dwordx4 v11, s[52:55], s39 offen lds
    s_mov_b32 s93, 0
    s_add_u32 s41, s47, 3
    s_lshl_b32 s29, s41, 1
    s_lshl_b32 s29, 3, s29
    s_or_b32 s93, s93, s29
    s_mov_b32 s90, 0x40000
L_nm_31p:
    s_andn2_b32 s88, s93, s92
    s_cbranch_scc0 L_nm_31
    s_sub_u32 s90, s90, 1
    s_cbranch_scc1 L_nm_31
    s_mov_b32 exec_lo, 0xffff0000
    s_mov_b32 exec_hi, 0xffff
    buffer_load_dword v252, v251, s[16:19], 0 offen sc0 sc1
    s_waitcnt vmcnt(0)
    v_sub_u32 v252, v252, v250
    v_cmp_eq_u32 vcc, 2, v252
    s_mov_b64 exec, -1
    s_lshr_b64 s[88:89], vcc, 16
    s_mov_b32 s92, s88
    s_branch L_nm_31p
L_nm_31:
    s_add_u32 m0, s37, 0
    s_lshl_b32 s29, s41, 12
    s_add_u32 s29, s29, s38
    buffer_load_dwordx4 v1, s[16:19], s29 offen offset:0 sc1 lds
    buffer_load_dwordx4 v1, s[16:19], s29 offen offset:1024 sc1 lds
    buffer_load_dwordx4 v1, s[16:19], s29 offen offset:2048 sc1 lds
    buffer_load_dwordx4 v1, s[16:19], s29 offen offset:3072 sc1 lds
    s_waitcnt vmcnt(16) lgkmcnt(0)
    s_barrier
    s_waitcnt vmcnt(8) lgkmcnt(0)
    s_barrier
    s_waitcnt vmcnt(0) lgkmcnt(0)
    s_barrier
    s_branch L_fin
L_compute:
    s_lshl_b32 s43, s26, 7
    s_add_u32 s43, s43, 30408704
    s_lshl_b32 s46, s26, 10
    s_lshl_b32 s29, s27, 2
    s_add_u32 s46, s46, s29
    s_add_u32 s46, s46, 30425088
    s_lshl_b32 s29, s24, 14
    s_sub_u32 s47, s46, s29
    s_add_u32 s47, s47, 16384
    v_lshl_add_u32 v20, v0, 7, s47
    s_add_u32 s47, s43, 2016
    v_lshl_add_u32 v21, v0, 2, s47
    v_cmp_gt_u32 vcc, 8, v0
    s_and_b32 s47, s3, 3
    s_lshl_b32 s47, s47, 1
    s_bfe_u32 s29, s2, 65541
    s_add_u32 s47, s47, s29
    v_cndmask_b32 v20, v21, v20, vcc
    s_lshl_b32 s48, s47, 1
    s_bfe_u32 s29, s2, 65540
    s_add_u32 s48, s48, s29
    s_mul_i32 s48, s48, 128
    s_add_u32 s48, s48, 30457792
    s_add_u32 s47, s48, 8192
    s_cmp_eq_u32 s99, 0
    s_cselect_b32 s47, s47, s48
    s_mul_i32 s29, s27, 2048
    s_add_u32 s47, s47, s29
    v_lshl_add_u32 v21, v0, 2, s47
    v_cmp_gt_u32 vcc, 16, v0
    s_lshl_b32 s29, s25, 7
    s_add_u32 s46, s46, s29
    s_lshl_b32 s29, s25, 2
    s_add_u32 s47, s43, s29
    v_cndmask_b32 v20, v21, v20, vcc
    s_add_u32 s47, s47, 2048
    s_cmp_eq_u32 s24, 0
    s_cselect_b32 s46, s47, s46
    v_and_b32 v21, 1, v0
    v_lshl_add_u32 v21, v21, 14, s46
    v_cmp_gt_u32 vcc, 48, v0
    s_lshl_b32 s46, s26, 10
    s_lshl_b32 s29, s25, 7
    s_add_u32 s46, s46, s29
    v_cndmask_b32 v20, v21, v20, vcc
    s_add_u32 s46, s46, 30441472
    v_and_b32 v21, 1, v0
    v_lshl_add_u32 v21, v21, 3, s46
    v_cmp_gt_u32 vcc, 52, v0
    s_nop 0
    s_nop 0
    v_cndmask_b32 v59, v21, v20, vcc
    buffer_load_dword v58, v59, s[16:19], 0 offen sc0 sc1
    s_lshr_b32 s36, s27, 1
    s_and_b32 s37, s27, 1
    v_and_b32 v8, 15, v0
    v_lshrrev_b32 v9, 4, v0
    v_lshrrev_b32 v10, 1, v8
    v_xor_b32 v10, v10, v9
    v_lshlrev_b32 v10, 4, v10
    s_lshl_b32 s29, s36, 14
    v_lshlrev_b32 v11, 7, v8
    v_add3_u32 v1, v11, v10, s29
    v_bfe_u32 v10, v0, 2, 2
    v_lshl_add_u32 v11, v9, 3, v10
    v_lshlrev_b32 v11, 7, v11
    v_lshrrev_b32 v10, 1, v10
    v_and_b32 v9, 1, v9
    v_xor_b32 v9, s37, v9
    v_lshl_add_u32 v10, v9, 1, v10
    v_lshl_add_u32 v11, v10, 5, v11
    v_and_b32 v10, 3, v0
    v_lshl_add_u32 v2, v10, 3, v11
    s_mov_b32 s30, 61440
    s_mov_b32 s31, 0
    v_add_u32 v4, s30, v1
    v_mov_b32 v6, v2
    v_xor_b32 v7, 32, v2
    s_mov_b32 s28, 16
    s_lshl_b32 s38, s26, 1
    s_add_u32 s38, s38, s37
    s_lshl_b32 s39, s25, 3
    s_lshl_b32 s29, s36, 2
    s_add_u32 s39, s39, s29
    s_lshl_b32 s40, s38, 6
    s_add_u32 s40, s40, s39
    s_mov_b32 s91, 0
    v_and_b32 v60, 15, v0
    v_lshrrev_b32 v61, 4, v0
    v_lshlrev_b32 v60, 4, v60
    v_lshl_add_u32 v60, v61, 9, v60
    s_mov_b32 s44, 1048744942
    s_mov_b32 s45, s44
    s_lshl_b32 s41, s40, 11
    s_lshr_b32 s29, s40, 3
    s_mul_i32 s29, s29, 768
    s_add_u32 s41, s41, s29
    s_add_u32 s41, s41, 46137344
    s_add_u32 s42, s41, 4096
    s_lshl_b32 s43, s40, 12
    s_add_u32 s43, s43, s29
    s_add_u32 s43, s43, 33554432
    s_lshl_b32 s29, s36, 14
    v_add_u32 v62, s29, v60
    s_lshl_b32 s29, s36, 13
    s_add_u32 s29, s29, 139264
    v_add_u32 v63, s29, v60
    v_pk_mov_b32 v[64:65], 0, 0
    v_pk_mov_b32 v[66:67], 0, 0
    v_pk_mov_b32 v[68:69], 0, 0
    v_pk_mov_b32 v[70:71], 0, 0
    v_pk_mov_b32 v[72:73], 0, 0
    v_pk_mov_b32 v[74:75], 0, 0
    v_pk_mov_b32 v[76:77], 0, 0
    v_pk_mov_b32 v[78:79], 0, 0
    v_pk_mov_b32 v[80:81], 0, 0
    v_pk_mov_b32 v[82:83], 0, 0
    v_pk_mov_b32 v[84:85], 0, 0
    v_pk_mov_b32 v[86:87], 0, 0
    v_pk_mov_b32 v[88:89], 0, 0
    v_pk_mov_b32 v[90:91], 0, 0
    v_pk_mov_b32 v[92:93], 0, 0
    v_pk_mov_b32 v[94:95], 0, 0
    v_pk_mov_b32 v[96:97], 0, 0
    v_pk_mov_b32 v[98:99], 0, 0
    v_pk_mov_b32 v[100:101], 0, 0
    v_pk_mov_b32 v[102:103], 0, 0
    v_pk_mov_b32 v[104:105], 0, 0
    v_pk_mov_b32 v[106:107], 0, 0
    v_pk_mov_b32 v[108:109], 0, 0
    v_pk_mov_b32 v[110:111], 0, 0
    v_pk_mov_b32 v[112:113], 0, 0
    v_pk_mov_b32 v[114:115], 0, 0
    v_pk_mov_b32 v[116:117], 0, 0
    v_pk_mov_b32 v[118:119], 0, 0
    v_pk_mov_b32 v[120:121], 0, 0
    v_pk_mov_b32 v[122:123], 0, 0
    v_pk_mov_b32 v[124:125], 0, 0
    v_pk_mov_b32 v[126:127], 0, 0
    v_pk_mov_b32 v[128:129], 0, 0
    v_pk_mov_b32 v[130:131], 0, 0
    v_pk_mov_b32 v[132:133], 0, 0
    v_pk_mov_b32 v[134:135], 0, 0
    v_pk_mov_b32 v[136:137], 0, 0
    v_pk_mov_b32 v[138:139], 0, 0
    v_pk_mov_b32 v[140:141], 0, 0
    v_pk_mov_b32 v[142:143], 0, 0
    v_pk_mov_b32 v[144:145], 0, 0
    v_pk_mov_b32 v[146:147], 0, 0
    v_pk_mov_b32 v[148:149], 0, 0
    v_pk_mov_b32 v[150:151], 0, 0
    v_pk_mov_b32 v[152:153], 0, 0
    v_pk_mov_b32 v[154:155], 0, 0
    v_pk_mov_b32 v[156:157], 0, 0
    v_pk_mov_b32 v[158:159], 0, 0
    v_pk_mov_b32 v[160:161], 0, 0
    v_pk_mov_b32 v[162:163], 0, 0
    v_pk_mov_b32 v[164:165], 0, 0
    v_pk_mov_b32 v[166:167], 0, 0
    v_pk_mov_b32 v[168:169], 0, 0
    v_pk_mov_b32 v[170:171], 0, 0
    v_pk_mov_b32 v[172:173], 0, 0
    v_pk_mov_b32 v[174:175], 0, 0
    v_pk_mov_b32 v[176:177], 0, 0
    v_pk_mov_b32 v[178:179], 0, 0
    v_pk_mov_b32 v[180:181], 0, 0
    v_pk_mov_b32 v[182:183], 0, 0
    v_pk_mov_b32 v[184:185], 0, 0
    v_pk_mov_b32 v[186:187], 0, 0
    v_pk_mov_b32 v[188:189], 0, 0
    v_pk_mov_b32 v[190:191], 0, 0
    v_pk_mov_b32 v[192:193], 0, 0
    v_pk_mov_b32 v[194:195], 0, 0
    v_pk_mov_b32 v[196:197], 0, 0
    v_pk_mov_b32 v[198:199], 0, 0
    v_pk_mov_b32 v[200:201], 0, 0
    v_pk_mov_b32 v[202:203], 0, 0
    v_pk_mov_b32 v[204:205], 0, 0
    v_pk_mov_b32 v[206:207], 0, 0
    v_pk_mov_b32 v[208:209], 0, 0
    v_pk_mov_b32 v[210:211], 0, 0
    v_pk_mov_b32 v[212:213], 0, 0
    v_pk_mov_b32 v[214:215], 0, 0
    v_pk_mov_b32 v[216:217], 0, 0
    v_pk_mov_b32 v[218:219], 0, 0
    v_pk_mov_b32 v[220:221], 0, 0
    v_pk_mov_b32 v[222:223], 0, 0
    v_pk_mov_b32 v[224:225], 0, 0
    v_pk_mov_b32 v[226:227], 0, 0
    v_pk_mov_b32 v[228:229], 0, 0
    v_pk_mov_b32 v[230:231], 0, 0
    v_pk_mov_b32 v[232:233], 0, 0
    v_pk_mov_b32 v[234:235], 0, 0
    v_pk_mov_b32 v[236:237], 0, 0
    v_pk_mov_b32 v[238:239], 0, 0
    v_pk_mov_b32 v[240:241], 0, 0
    v_pk_mov_b32 v[242:243], 0, 0
    v_pk_mov_b32 v[244:245], 0, 0
    v_pk_mov_b32 v[246:247], 0, 0
    v_pk_mov_b32 v[248:249], 0, 0
    v_pk_mov_b32 v[250:251], 0, 0
    v_pk_mov_b32 v[252:253], 0, 0
    v_pk_mov_b32 v[254:255], 0, 0
    s_waitcnt vmcnt(0)
    s_lshl_b32 s29, s27, 9
    s_add_u32 s29, s29, 159744
    v_lshl_add_u32 v20, v0, 3, s29
    ds_write_b64 v20, v[58:59]
    s_waitcnt lgkmcnt(0)
    s_barrier
    ds_read_b64_tr_b16 v[36:37], v6 offset:0
    ds_read_b64_tr_b16 v[38:39], v6 offset:512
    ds_read_b64_tr_b16 v[40:41], v7 offset:0
    ds_read_b64_tr_b16 v[42:43], v7 offset:512
    ds_read_b64_tr_b16 v[44:45], v6 offset:4096
    ds_read_b64_tr_b16 v[46:47], v6 offset:4608
    ds_read_b128 v[8:11], v4 offset:0
    ds_read_b128 v[12:15], v4 offset:2048
    ds_read_b64_tr_b16 v[24:25], v7 offset:4096
    ds_read_b64_tr_b16 v[26:27], v7 offset:4608
    ds_read_b64_tr_b16 v[28:29], v6 offset:8192
    ds_read_b64_tr_b16 v[30:31], v6 offset:8704
    ds_read_b64_tr_b16 v[32:33], v7 offset:8192
    ds_read_b64_tr_b16 v[34:35], v7 offset:8704
    ds_read_b128 v[16:19], v4 offset:4096
.p2align 6
L_p1_loop:
    s_waitcnt lgkmcnt(8)
    v_mfma_f32_16x16x32_bf16 v[64:67], v[36:39], v[8:11], v[64:67]
    ds_read_b128 v[20:23], v4 offset:6144
    v_mfma_f32_16x16x32_bf16 v[68:71], v[40:43], v[8:11], v[68:71]
    s_add_u32 s31, s31, 12288
    v_mfma_f32_16x16x32_bf16 v[128:131], v[44:47], v[8:11], v[128:131]
    s_waitcnt lgkmcnt(8)
    v_mfma_f32_16x16x32_bf16 v[72:75], v[36:39], v[12:15], v[72:75]
    s_cmp_eq_u32 s31, 61440
    v_mfma_f32_16x16x32_bf16 v[76:79], v[40:43], v[12:15], v[76:79]
    s_cselect_b32 s31, 0, s31
    v_mfma_f32_16x16x32_bf16 v[136:139], v[44:47], v[12:15], v[136:139]
    s_waitcnt lgkmcnt(6)
    v_mfma_f32_16x16x32_bf16 v[132:135], v[24:27], v[8:11], v[132:135]
    s_waitcnt lgkmcnt(4)
    v_mfma_f32_16x16x32_bf16 v[192:195], v[8:11], v[28:31], v[192:195]
    s_waitcnt lgkmcnt(2)
    v_mfma_f32_16x16x32_bf16 v[200:203], v[8:11], v[32:35], v[200:203]
    v_mfma_f32_16x16x32_bf16 v[140:143], v[24:27], v[12:15], v[140:143]
    ds_read_b128 v[8:11], v4 offset:8192
    v_mfma_f32_16x16x32_bf16 v[196:199], v[12:15], v[28:31], v[196:199]
    v_add_u32 v6, s31, v2
    v_mfma_f32_16x16x32_bf16 v[204:207], v[12:15], v[32:35], v[204:207]
    s_waitcnt lgkmcnt(2)
    v_mfma_f32_16x16x32_bf16 v[80:83], v[36:39], v[16:19], v[80:83]
    ds_read_b128 v[12:15], v4 offset:10240
    v_mfma_f32_16x16x32_bf16 v[84:87], v[40:43], v[16:19], v[84:87]
    v_xor_b32 v7, 32, v6
    v_mfma_f32_16x16x32_bf16 v[144:147], v[44:47], v[16:19], v[144:147]
    v_mfma_f32_16x16x32_bf16 v[148:151], v[24:27], v[16:19], v[148:151]
    v_mfma_f32_16x16x32_bf16 v[208:211], v[16:19], v[28:31], v[208:211]
    v_mfma_f32_16x16x32_bf16 v[216:219], v[16:19], v[32:35], v[216:219]
    s_waitcnt lgkmcnt(2)
    v_mfma_f32_16x16x32_bf16 v[88:91], v[36:39], v[20:23], v[88:91]
    ds_read_b128 v[16:19], v4 offset:12288
    v_mfma_f32_16x16x32_bf16 v[92:95], v[40:43], v[20:23], v[92:95]
    v_xor_b32 v5, 64, v4
    v_mfma_f32_16x16x32_bf16 v[152:155], v[44:47], v[20:23], v[152:155]
    v_mfma_f32_16x16x32_bf16 v[156:159], v[24:27], v[20:23], v[156:159]
    s_barrier
    v_mfma_f32_16x16x32_bf16 v[212:215], v[20:23], v[28:31], v[212:215]
    v_mfma_f32_16x16x32_bf16 v[220:223], v[20:23], v[32:35], v[220:223]
    s_waitcnt lgkmcnt(2)
    v_mfma_f32_16x16x32_bf16 v[96:99], v[36:39], v[8:11], v[96:99]
    ds_read_b128 v[20:23], v4 offset:14336
    v_mfma_f32_16x16x32_bf16 v[100:103], v[40:43], v[8:11], v[100:103]
    ds_read_b64_tr_b16 v[48:49], v6 offset:0
    v_mfma_f32_16x16x32_bf16 v[160:163], v[44:47], v[8:11], v[160:163]
    ds_read_b64_tr_b16 v[50:51], v6 offset:512
    v_mfma_f32_16x16x32_bf16 v[164:167], v[24:27], v[8:11], v[164:167]
    ds_read_b64_tr_b16 v[52:53], v7 offset:0
    v_mfma_f32_16x16x32_bf16 v[224:227], v[8:11], v[28:31], v[224:227]
    ds_read_b64_tr_b16 v[54:55], v7 offset:512
    v_mfma_f32_16x16x32_bf16 v[232:235], v[8:11], v[32:35], v[232:235]
    s_waitcnt lgkmcnt(6)
    v_mfma_f32_16x16x32_bf16 v[104:107], v[36:39], v[12:15], v[104:107]
    ds_read_b64_tr_b16 v[56:57], v6 offset:4096
    v_mfma_f32_16x16x32_bf16 v[108:111], v[40:43], v[12:15], v[108:111]
    ds_read_b64_tr_b16 v[58:59], v6 offset:4608
    v_mfma_f32_16x16x32_bf16 v[168:171], v[44:47], v[12:15], v[168:171]
    ds_read_b128 v[8:11], v5 offset:0
    v_mfma_f32_16x16x32_bf16 v[172:175], v[24:27], v[12:15], v[172:175]
    v_mfma_f32_16x16x32_bf16 v[228:231], v[12:15], v[28:31], v[228:231]
    v_mfma_f32_16x16x32_bf16 v[236:239], v[12:15], v[32:35], v[236:239]
    s_waitcnt lgkmcnt(8)
    v_mfma_f32_16x16x32_bf16 v[180:183], v[24:27], v[16:19], v[180:183]
    ds_read_b128 v[12:15], v5 offset:2048
    v_mfma_f32_16x16x32_bf16 v[240:243], v[16:19], v[28:31], v[240:243]
    v_mfma_f32_16x16x32_bf16 v[248:251], v[16:19], v[32:35], v[248:251]
    s_waitcnt lgkmcnt(8)
    v_mfma_f32_16x16x32_bf16 v[188:191], v[24:27], v[20:23], v[188:191]
    ds_read_b64_tr_b16 v[24:25], v7 offset:4096
    v_mfma_f32_16x16x32_bf16 v[244:247], v[20:23], v[28:31], v[244:247]
    ds_read_b64_tr_b16 v[26:27], v7 offset:4608
    v_mfma_f32_16x16x32_bf16 v[252:255], v[20:23], v[32:35], v[252:255]
    ds_read_b64_tr_b16 v[28:29], v6 offset:8192
    v_mfma_f32_16x16x32_bf16 v[112:115], v[36:39], v[16:19], v[112:115]
    ds_read_b64_tr_b16 v[30:31], v6 offset:8704
    v_mfma_f32_16x16x32_bf16 v[116:119], v[40:43], v[16:19], v[116:119]
    ds_read_b64_tr_b16 v[32:33], v7 offset:8192
    v_mfma_f32_16x16x32_bf16 v[176:179], v[44:47], v[16:19], v[176:179]
    ds_read_b64_tr_b16 v[34:35], v7 offset:8704
    v_mfma_f32_16x16x32_bf16 v[120:123], v[36:39], v[20:23], v[120:123]
    ds_read_b128 v[16:19], v5 offset:4096
    v_mfma_f32_16x16x32_bf16 v[124:127], v[40:43], v[20:23], v[124:127]
    s_cmp_eq_u32 s28, 1
    v_mfma_f32_16x16x32_bf16 v[184:187], v[44:47], v[20:23], v[184:187]
    s_cbranch_scc1 L_p1_last
    s_waitcnt lgkmcnt(8)
    v_mfma_f32_16x16x32_bf16 v[64:67], v[48:51], v[8:11], v[64:67]
    ds_read_b128 v[20:23], v5 offset:6144
    v_mfma_f32_16x16x32_bf16 v[68:71], v[52:55], v[8:11], v[68:71]
    s_add_u32 s31, s31, 12288
    v_mfma_f32_16x16x32_bf16 v[128:131], v[56:59], v[8:11], v[128:131]
    s_waitcnt lgkmcnt(8)
    v_mfma_f32_16x16x32_bf16 v[72:75], v[48:51], v[12:15], v[72:75]
    s_cmp_eq_u32 s31, 61440
    v_mfma_f32_16x16x32_bf16 v[76:79], v[52:55], v[12:15], v[76:79]
    s_cselect_b32 s31, 0, s31
    v_mfma_f32_16x16x32_bf16 v[136:139], v[56:59], v[12:15], v[136:139]
    s_waitcnt lgkmcnt(6)
    v_mfma_f32_16x16x32_bf16 v[132:135], v[24:27], v[8:11], v[132:135]
    s_waitcnt lgkmcnt(4)
    v_mfma_f32_16x16x32_bf16 v[192:195], v[8:11], v[28:31], v[192:195]
    s_waitcnt lgkmcnt(2)
    v_mfma_f32_16x16x32_bf16 v[200:203], v[8:11], v[32:35], v[200:203]
    v_mfma_f32_16x16x32_bf16 v[140:143], v[24:27], v[12:15], v[140:143]
    ds_read_b128 v[8:11], v5 offset:8192
    v_mfma_f32_16x16x32_bf16 v[196:199], v[12:15], v[28:31], v[196:199]
    v_add_u32 v6, s31, v2
    v_mfma_f32_16x16x32_bf16 v[204:207], v[12:15], v[32:35], v[204:207]
    s_waitcnt lgkmcnt(2)
    v_mfma_f32_16x16x32_bf16 v[80:83], v[48:51], v[16:19], v[80:83]
    ds_read_b128 v[12:15], v5 offset:10240
    v_mfma_f32_16x16x32_bf16 v[84:87], v[52:55], v[16:19], v[84:87]
    v_xor_b32 v7, 32, v6
    v_mfma_f32_16x16x32_bf16 v[144:147], v[56:59], v[16:19], v[144:147]
    s_add_u32 s30, s30, 32768
    v_mfma_f32_16x16x32_bf16 v[148:151], v[24:27], v[16:19], v[148:151]
    s_cmp_eq_u32 s30, 159744
    v_mfma_f32_16x16x32_bf16 v[208:211], v[16:19], v[28:31], v[208:211]
    s_cselect_b32 s30, 61440, s30
    v_mfma_f32_16x16x32_bf16 v[216:219], v[16:19], v[32:35], v[216:219]
    s_waitcnt lgkmcnt(2)
    v_mfma_f32_16x16x32_bf16 v[88:91], v[48:51], v[20:23], v[88:91]
    ds_read_b128 v[16:19], v5 offset:12288
    v_mfma_f32_16x16x32_bf16 v[92:95], v[52:55], v[20:23], v[92:95]
    v_add_u32 v4, s30, v1
    v_mfma_f32_16x16x32_bf16 v[152:155], v[56:59], v[20:23], v[152:155]
    v_mfma_f32_16x16x32_bf16 v[156:159], v[24:27], v[20:23], v[156:159]
    s_barrier
    v_mfma_f32_16x16x32_bf16 v[212:215], v[20:23], v[28:31], v[212:215]
    v_mfma_f32_16x16x32_bf16 v[220:223], v[20:23], v[32:35], v[220:223]
    s_waitcnt lgkmcnt(2)
    v_mfma_f32_16x16x32_bf16 v[96:99], v[48:51], v[8:11], v[96:99]
    ds_read_b128 v[20:23], v5 offset:14336
    v_mfma_f32_16x16x32_bf16 v[100:103], v[52:55], v[8:11], v[100:103]
    ds_read_b64_tr_b16 v[36:37], v6 offset:0
    v_mfma_f32_16x16x32_bf16 v[160:163], v[56:59], v[8:11], v[160:163]
    ds_read_b64_tr_b16 v[38:39], v6 offset:512
    v_mfma_f32_16x16x32_bf16 v[164:167], v[24:27], v[8:11], v[164:167]
    ds_read_b64_tr_b16 v[40:41], v7 offset:0
    v_mfma_f32_16x16x32_bf16 v[224:227], v[8:11], v[28:31], v[224:227]
    ds_read_b64_tr_b16 v[42:43], v7 offset:512
    v_mfma_f32_16x16x32_bf16 v[232:235], v[8:11], v[32:35], v[232:235]
    s_waitcnt lgkmcnt(6)
    v_mfma_f32_16x16x32_bf16 v[104:107], v[48:51], v[12:15], v[104:107]
    ds_read_b64_tr_b16 v[44:45], v6 offset:4096
    v_mfma_f32_16x16x32_bf16 v[108:111], v[52:55], v[12:15], v[108:111]
    ds_read_b64_tr_b16 v[46:47], v6 offset:4608
    v_mfma_f32_16x16x32_bf16 v[168:171], v[56:59], v[12:15], v[168:171]
    ds_read_b128 v[8:11], v4 offset:0
    v_mfma_f32_16x16x32_bf16 v[172:175], v[24:27], v[12:15], v[172:175]
    v_mfma_f32_16x16x32_bf16 v[228:231], v[12:15], v[28:31], v[228:231]
    v_mfma_f32_16x16x32_bf16 v[236:239], v[12:15], v[32:35], v[236:239]
    s_waitcnt lgkmcnt(8)
    v_mfma_f32_16x16x32_bf16 v[180:183], v[24:27], v[16:19], v[180:183]
    ds_read_b128 v[12:15], v4 offset:2048
    v_mfma_f32_16x16x32_bf16 v[240:243], v[16:19], v[28:31], v[240:243]
    s_sub_u32 s28, s28, 1
    v_mfma_f32_16x16x32_bf16 v[248:251], v[16:19], v[32:35], v[248:251]
    s_waitcnt lgkmcnt(8)
    v_mfma_f32_16x16x32_bf16 v[188:191], v[24:27], v[20:23], v[188:191]
    ds_read_b64_tr_b16 v[24:25], v7 offset:4096
    v_mfma_f32_16x16x32_bf16 v[244:247], v[20:23], v[28:31], v[244:247]
    ds_read_b64_tr_b16 v[26:27], v7 offset:4608
    v_mfma_f32_16x16x32_bf16 v[252:255], v[20:23], v[32:35], v[252:255]
    ds_read_b64_tr_b16 v[28:29], v6 offset:8192
    v_mfma_f32_16x16x32_bf16 v[112:115], v[48:51], v[16:19], v[112:115]
    ds_read_b64_tr_b16 v[30:31], v6 offset:8704
    v_mfma_f32_16x16x32_bf16 v[116:119], v[52:55], v[16:19], v[116:119]
    ds_read_b64_tr_b16 v[32:33], v7 offset:8192
    v_mfma_f32_16x16x32_bf16 v[176:179], v[56:59], v[16:19], v[176:179]
    ds_read_b64_tr_b16 v[34:35], v7 offset:8704
    v_mfma_f32_16x16x32_bf16 v[120:123], v[48:51], v[20:23], v[120:123]
    ds_read_b128 v[16:19], v4 offset:4096
    v_mfma_f32_16x16x32_bf16 v[124:127], v[52:55], v[20:23], v[124:127]
    s_cmp_lg_u32 s28, 0
    v_mfma_f32_16x16x32_bf16 v[184:187], v[56:59], v[20:23], v[184:187]
    s_branch L_p1_loop
L_p1_last:
    v_lshlrev_b32 v1, 4, v0
    s_cmp_eq_u32 s24, 0
    s_cbranch_scc1 L_p1_epiA
    s_cmp_lg_u32 s37, 0
    s_cbranch_scc1 L_p1_hd1
    s_waitcnt lgkmcnt(8)
    v_mfma_f32_16x16x32_bf16 v[64:67], v[48:51], v[8:11], v[64:67]
    ds_read_b128 v[20:23], v5 offset:6144
    v_mfma_f32_16x16x32_bf16 v[68:71], v[52:55], v[8:11], v[68:71]
    v_mfma_f32_16x16x32_bf16 v[128:131], v[56:59], v[8:11], v[128:131]
    s_waitcnt lgkmcnt(8)
    v_mfma_f32_16x16x32_bf16 v[72:75], v[48:51], v[12:15], v[72:75]
    v_mfma_f32_16x16x32_bf16 v[76:79], v[52:55], v[12:15], v[76:79]
    v_mfma_f32_16x16x32_bf16 v[136:139], v[56:59], v[12:15], v[136:139]
    s_waitcnt lgkmcnt(6)
    v_mfma_f32_16x16x32_bf16 v[132:135], v[24:27], v[8:11], v[132:135]
    s_waitcnt lgkmcnt(4)
    v_mfma_f32_16x16x32_bf16 v[192:195], v[8:11], v[28:31], v[192:195]
    s_waitcnt lgkmcnt(2)
    v_mfma_f32_16x16x32_bf16 v[200:203], v[8:11], v[32:35], v[200:203]
    v_mfma_f32_16x16x32_bf16 v[140:143], v[24:27], v[12:15], v[140:143]
    ds_read_b128 v[8:11], v5 offset:8192
    v_mfma_f32_16x16x32_bf16 v[196:199], v[12:15], v[28:31], v[196:199]
    s_barrier
    v_mfma_f32_16x16x32_bf16 v[204:207], v[12:15], v[32:35], v[204:207]
    s_waitcnt lgkmcnt(2)
    v_mfma_f32_16x16x32_bf16 v[80:83], v[48:51], v[16:19], v[80:83]
    ds_read_b128 v[12:15], v5 offset:10240
    v_mfma_f32_16x16x32_bf16 v[84:87], v[52:55], v[16:19], v[84:87]
    v_mfma_f32_16x16x32_bf16 v[144:147], v[56:59], v[16:19], v[144:147]
    v_mfma_f32_16x16x32_bf16 v[148:151], v[24:27], v[16:19], v[148:151]
    v_mfma_f32_16x16x32_bf16 v[208:211], v[16:19], v[28:31], v[208:211]
    v_mfma_f32_16x16x32_bf16 v[216:219], v[16:19], v[32:35], v[216:219]
    v_cvt_pk_bf16_f32 v128, v128, v129
    v_cvt_pk_bf16_f32 v129, v130, v131
    s_waitcnt lgkmcnt(2)
    v_mfma_f32_16x16x32_bf16 v[88:91], v[48:51], v[20:23], v[88:91]
    ds_read_b128 v[16:19], v5 offset:12288
    v_cvt_pk_bf16_f32 v130, v132, v133
    v_mfma_f32_16x16x32_bf16 v[92:95], v[52:55], v[20:23], v[92:95]
    v_cvt_pk_bf16_f32 v131, v134, v135
    v_cvt_pk_bf16_f32 v132, v136, v137
    v_mfma_f32_16x16x32_bf16 v[152:155], v[56:59], v[20:23], v[152:155]
    v_cvt_pk_bf16_f32 v133, v138, v139
    v_cvt_pk_bf16_f32 v134, v140, v141
    v_mfma_f32_16x16x32_bf16 v[156:159], v[24:27], v[20:23], v[156:159]
    v_cvt_pk_bf16_f32 v135, v142, v143
    ds_write_b128 v62, v[128:131] offset:0
    v_mfma_f32_16x16x32_bf16 v[212:215], v[20:23], v[28:31], v[212:215]
    ds_write_b128 v62, v[132:135] offset:256
    v_cvt_pk_bf16_f32 v192, v192, v193
    v_mfma_f32_16x16x32_bf16 v[220:223], v[20:23], v[32:35], v[220:223]
    v_cvt_pk_bf16_f32 v193, v194, v195
    v_cvt_pk_bf16_f32 v194, v196, v197
    s_waitcnt lgkmcnt(4)
    v_mfma_f32_16x16x32_bf16 v[96:99], v[48:51], v[8:11], v[96:99]
    ds_read_b128 v[20:23], v5 offset:14336
    v_cvt_pk_bf16_f32 v195, v198, v199
    v_mfma_f32_16x16x32_bf16 v[100:103], v[52:55], v[8:11], v[100:103]
    v_cvt_pk_bf16_f32 v196, v200, v201
    v_cvt_pk_bf16_f32 v197, v202, v203
    v_mfma_f32_16x16x32_bf16 v[160:163], v[56:59], v[8:11], v[160:163]
    v_cvt_pk_bf16_f32 v198, v204, v205
    v_cvt_pk_bf16_f32 v199, v206, v207
    v_mfma_f32_16x16x32_bf16 v[164:167], v[24:27], v[8:11], v[164:167]
    ds_write_b128 v62, v[192:195] offset:2048
    ds_write_b128 v62, v[196:199] offset:2304
    v_mfma_f32_16x16x32_bf16 v[224:227], v[8:11], v[28:31], v[224:227]
    v_mfma_f32_16x16x32_bf16 v[232:235], v[8:11], v[32:35], v[232:235]
    v_cvt_pk_bf16_f32 v144, v144, v145
    v_cvt_pk_bf16_f32 v145, v146, v147
    s_waitcnt lgkmcnt(6)
    v_mfma_f32_16x16x32_bf16 v[104:107], v[48:51], v[12:15], v[104:107]
    v_cvt_pk_bf16_f32 v146, v148, v149
    v_cvt_pk_bf16_f32 v147, v150, v151
    v_mfma_f32_16x16x32_bf16 v[108:111], v[52:55], v[12:15], v[108:111]
    v_cvt_pk_bf16_f32 v148, v152, v153
    v_cvt_pk_bf16_f32 v149, v154, v155
    v_mfma_f32_16x16x32_bf16 v[168:171], v[56:59], v[12:15], v[168:171]
    v_cvt_pk_bf16_f32 v150, v156, v157
    v_cvt_pk_bf16_f32 v151, v158, v159
    v_mfma_f32_16x16x32_bf16 v[172:175], v[24:27], v[12:15], v[172:175]
    ds_write_b128 v62, v[144:147] offset:4096
    ds_write_b128 v62, v[148:151] offset:4352
    v_mfma_f32_16x16x32_bf16 v[228:231], v[12:15], v[28:31], v[228:231]
    v_cvt_pk_bf16_f32 v208, v208, v209
    v_cvt_pk_bf16_f32 v209, v210, v211
    v_mfma_f32_16x16x32_bf16 v[236:239], v[12:15], v[32:35], v[236:239]
    v_cvt_pk_bf16_f32 v210, v212, v213
    v_cvt_pk_bf16_f32 v211, v214, v215
    s_waitcnt lgkmcnt(7)
    v_mfma_f32_16x16x32_bf16 v[180:183], v[24:27], v[16:19], v[180:183]
    v_cvt_pk_bf16_f32 v212, v216, v217
    v_cvt_pk_bf16_f32 v213, v218, v219
    v_mfma_f32_16x16x32_bf16 v[240:243], v[16:19], v[28:31], v[240:243]
    v_cvt_pk_bf16_f32 v214, v220, v221
    v_cvt_pk_bf16_f32 v215, v222, v223
    v_mfma_f32_16x16x32_bf16 v[248:251], v[16:19], v[32:35], v[248:251]
    ds_write_b128 v62, v[208:211] offset:6144
    ds_write_b128 v62, v[212:215] offset:6400
    s_waitcnt lgkmcnt(6)
    v_mfma_f32_16x16x32_bf16 v[188:191], v[24:27], v[20:23], v[188:191]
    v_mfma_f32_16x16x32_bf16 v[244:247], v[20:23], v[28:31], v[244:247]
    v_mfma_f32_16x16x32_bf16 v[252:255], v[20:23], v[32:35], v[252:255]
    v_cvt_pk_bf16_f32 v160, v160, v161
    v_cvt_pk_bf16_f32 v161, v162, v163
    v_mfma_f32_16x16x32_bf16 v[112:115], v[48:51], v[16:19], v[112:115]
    v_cvt_pk_bf16_f32 v162, v164, v165
    v_cvt_pk_bf16_f32 v163, v166, v167
    v_mfma_f32_16x16x32_bf16 v[116:119], v[52:55], v[16:19], v[116:119]
    v_cvt_pk_bf16_f32 v164, v168, v169
    v_cvt_pk_bf16_f32 v165, v170, v171
    v_mfma_f32_16x16x32_bf16 v[176:179], v[56:59], v[16:19], v[176:179]
    v_cvt_pk_bf16_f32 v166, v172, v173
    v_cvt_pk_bf16_f32 v167, v174, v175
    v_mfma_f32_16x16x32_bf16 v[120:123], v[48:51], v[20:23], v[120:123]
    ds_write_b128 v62, v[160:163] offset:8192
    ds_write_b128 v62, v[164:167] offset:8448
    v_mfma_f32_16x16x32_bf16 v[124:127], v[52:55], v[20:23], v[124:127]
    v_cvt_pk_bf16_f32 v224, v224, v225
    v_cvt_pk_bf16_f32 v225, v226, v227
    v_mfma_f32_16x16x32_bf16 v[184:187], v[56:59], v[20:23], v[184:187]
    v_cvt_pk_bf16_f32 v226, v228, v229
    v_cvt_pk_bf16_f32 v227, v230, v231
    v_cvt_pk_bf16_f32 v228, v232, v233
    v_cvt_pk_bf16_f32 v229, v234, v235
    v_cvt_pk_bf16_f32 v230, v236, v237
    v_cvt_pk_bf16_f32 v231, v238, v239
    ds_write_b128 v62, v[224:227] offset:10240
    ds_write_b128 v62, v[228:231] offset:10496
    v_cvt_pk_bf16_f32 v176, v176, v177
    v_cvt_pk_bf16_f32 v177, v178, v179
    v_cvt_pk_bf16_f32 v178, v180, v181
    v_cvt_pk_bf16_f32 v179, v182, v183
    v_cvt_pk_bf16_f32 v180, v184, v185
    v_cvt_pk_bf16_f32 v181, v186, v187
    v_cvt_pk_bf16_f32 v182, v188, v189
    v_cvt_pk_bf16_f32 v183, v190, v191
    ds_write_b128 v62, v[176:179] offset:12288
    ds_write_b128 v62, v[180:183] offset:12544
    v_cvt_pk_bf16_f32 v240, v240, v241
    v_cvt_pk_bf16_f32 v241, v242, v243
    v_cvt_pk_bf16_f32 v242, v244, v245
    v_cvt_pk_bf16_f32 v243, v246, v247
    v_cvt_pk_bf16_f32 v244, v248, v249
    v_cvt_pk_bf16_f32 v245, v250, v251
    v_cvt_pk_bf16_f32 v246, v252, v253
    v_cvt_pk_bf16_f32 v247, v254, v255
    ds_write_b128 v62, v[240:243] offset:14336
    ds_write_b128 v62, v[244:247] offset:14592
    s_waitcnt lgkmcnt(0)
    s_barrier
    v_pk_mul_f32 v[64:65], v[64:65], s[44:45]
    v_pk_mul_f32 v[66:67], v[66:67], s[44:45]
    v_pk_mul_f32 v[68:69], v[68:69], s[44:45]
    v_pk_mul_f32 v[70:71], v[70:71], s[44:45]
    v_pk_mul_f32 v[72:73], v[72:73], s[44:45]
    v_pk_mul_f32 v[74:75], v[74:75], s[44:45]
    v_pk_mul_f32 v[76:77], v[76:77], s[44:45]
    v_pk_mul_f32 v[78:79], v[78:79], s[44:45]
    v_cvt_pk_bf16_f32 v64, v64, v65
    v_cvt_pk_bf16_f32 v65, v66, v67
    v_cvt_pk_bf16_f32 v66, v68, v69
    v_cvt_pk_bf16_f32 v67, v70, v71
    v_cvt_pk_bf16_f32 v68, v72, v73
    v_cvt_pk_bf16_f32 v69, v74, v75
    v_cvt_pk_bf16_f32 v70, v76, v77
    v_cvt_pk_bf16_f32 v71, v78, v79
    ds_write_b128 v63, v[64:67] offset:0
    ds_write_b128 v63, v[68:71] offset:256
    v_pk_mul_f32 v[80:81], v[80:81], s[44:45]
    v_pk_mul_f32 v[82:83], v[82:83], s[44:45]
    v_pk_mul_f32 v[84:85], v[84:85], s[44:45]
    v_pk_mul_f32 v[86:87], v[86:87], s[44:45]
    v_pk_mul_f32 v[88:89], v[88:89], s[44:45]
    v_pk_mul_f32 v[90:91], v[90:91], s[44:45]
    v_pk_mul_f32 v[92:93], v[92:93], s[44:45]
    v_pk_mul_f32 v[94:95], v[94:95], s[44:45]
    v_cvt_pk_bf16_f32 v80, v80, v81
    v_cvt_pk_bf16_f32 v81, v82, v83
    v_cvt_pk_bf16_f32 v82, v84, v85
    v_cvt_pk_bf16_f32 v83, v86, v87
    v_cvt_pk_bf16_f32 v84, v88, v89
    v_cvt_pk_bf16_f32 v85, v90, v91
    v_cvt_pk_bf16_f32 v86, v92, v93
    v_cvt_pk_bf16_f32 v87, v94, v95
    ds_write_b128 v63, v[80:83] offset:2048
    ds_write_b128 v63, v[84:87] offset:2304
    v_pk_mul_f32 v[96:97], v[96:97], s[44:45]
    v_pk_mul_f32 v[98:99], v[98:99], s[44:45]
    v_pk_mul_f32 v[100:101], v[100:101], s[44:45]
    v_pk_mul_f32 v[102:103], v[102:103], s[44:45]
    v_pk_mul_f32 v[104:105], v[104:105], s[44:45]
    v_pk_mul_f32 v[106:107], v[106:107], s[44:45]
    v_pk_mul_f32 v[108:109], v[108:109], s[44:45]
    v_pk_mul_f32 v[110:111], v[110:111], s[44:45]
    v_cvt_pk_bf16_f32 v96, v96, v97
    v_cvt_pk_bf16_f32 v97, v98, v99
    v_cvt_pk_bf16_f32 v98, v100, v101
    v_cvt_pk_bf16_f32 v99, v102, v103
    v_cvt_pk_bf16_f32 v100, v104, v105
    v_cvt_pk_bf16_f32 v101, v106, v107
    v_cvt_pk_bf16_f32 v102, v108, v109
    v_cvt_pk_bf16_f32 v103, v110, v111
    ds_write_b128 v63, v[96:99] offset:4096
    ds_write_b128 v63, v[100:103] offset:4352
    v_pk_mul_f32 v[112:113], v[112:113], s[44:45]
    v_pk_mul_f32 v[114:115], v[114:115], s[44:45]
    v_pk_mul_f32 v[116:117], v[116:117], s[44:45]
    v_pk_mul_f32 v[118:119], v[118:119], s[44:45]
    v_pk_mul_f32 v[120:121], v[120:121], s[44:45]
    v_pk_mul_f32 v[122:123], v[122:123], s[44:45]
    v_pk_mul_f32 v[124:125], v[124:125], s[44:45]
    v_pk_mul_f32 v[126:127], v[126:127], s[44:45]
    v_cvt_pk_bf16_f32 v112, v112, v113
    v_cvt_pk_bf16_f32 v113, v114, v115
    v_cvt_pk_bf16_f32 v114, v116, v117
    v_cvt_pk_bf16_f32 v115, v118, v119
    v_cvt_pk_bf16_f32 v116, v120, v121
    v_cvt_pk_bf16_f32 v117, v122, v123
    v_cvt_pk_bf16_f32 v118, v124, v125
    v_cvt_pk_bf16_f32 v119, v126, v127
    ds_write_b128 v63, v[112:115] offset:6144
    ds_write_b128 v63, v[116:119] offset:6400
    s_branch L_p1_done
L_p1_hd1:
    s_mov_b32 s91, 3
    s_waitcnt lgkmcnt(8)
    v_mfma_f32_16x16x32_bf16 v[64:67], v[48:51], v[8:11], v[64:67]
    ds_read_b128 v[20:23], v5 offset:6144
    v_mfma_f32_16x16x32_bf16 v[68:71], v[52:55], v[8:11], v[68:71]
    v_mfma_f32_16x16x32_bf16 v[128:131], v[56:59], v[8:11], v[128:131]
    s_waitcnt lgkmcnt(8)
    v_mfma_f32_16x16x32_bf16 v[72:75], v[48:51], v[12:15], v[72:75]
    v_mfma_f32_16x16x32_bf16 v[76:79], v[52:55], v[12:15], v[76:79]
    v_mfma_f32_16x16x32_bf16 v[136:139], v[56:59], v[12:15], v[136:139]
    s_waitcnt lgkmcnt(6)
    v_mfma_f32_16x16x32_bf16 v[132:135], v[24:27], v[8:11], v[132:135]
    s_waitcnt lgkmcnt(4)
    v_mfma_f32_16x16x32_bf16 v[192:195], v[8:11], v[28:31], v[192:195]
    s_waitcnt lgkmcnt(2)
    v_mfma_f32_16x16x32_bf16 v[200:203], v[8:11], v[32:35], v[200:203]
    v_mfma_f32_16x16x32_bf16 v[140:143], v[24:27], v[12:15], v[140:143]
    ds_read_b128 v[8:11], v5 offset:8192
    v_mfma_f32_16x16x32_bf16 v[196:199], v[12:15], v[28:31], v[196:199]
    s_barrier
    v_mfma_f32_16x16x32_bf16 v[204:207], v[12:15], v[32:35], v[204:207]
    s_waitcnt lgkmcnt(2)
    v_mfma_f32_16x16x32_bf16 v[80:83], v[48:51], v[16:19], v[80:83]
    ds_read_b128 v[12:15], v5 offset:10240
    v_mfma_f32_16x16x32_bf16 v[84:87], v[52:55], v[16:19], v[84:87]
    v_mfma_f32_16x16x32_bf16 v[144:147], v[56:59], v[16:19], v[144:147]
    v_mfma_f32_16x16x32_bf16 v[148:151], v[24:27], v[16:19], v[148:151]
    v_mfma_f32_16x16x32_bf16 v[208:211], v[16:19], v[28:31], v[208:211]
    v_mfma_f32_16x16x32_bf16 v[216:219], v[16:19], v[32:35], v[216:219]
    v_cvt_pk_bf16_f32 v128, v128, v129
    v_cvt_pk_bf16_f32 v129, v130, v131
    s_waitcnt lgkmcnt(2)
    v_mfma_f32_16x16x32_bf16 v[88:91], v[48:51], v[20:23], v[88:91]
    ds_read_b128 v[16:19], v5 offset:12288
    v_cvt_pk_bf16_f32 v130, v132, v133
    v_mfma_f32_16x16x32_bf16 v[92:95], v[52:55], v[20:23], v[92:95]
    v_cvt_pk_bf16_f32 v131, v134, v135
    v_cvt_pk_bf16_f32 v132, v136, v137
    v_mfma_f32_16x16x32_bf16 v[152:155], v[56:59], v[20:23], v[152:155]
    v_cvt_pk_bf16_f32 v133, v138, v139
    v_cvt_pk_bf16_f32 v134, v140, v141
    v_mfma_f32_16x16x32_bf16 v[156:159], v[24:27], v[20:23], v[156:159]
    v_cvt_pk_bf16_f32 v135, v142, v143
    buffer_store_dwordx4 v[128:131], v60, s[16:19], s43 offen sc0 sc1
    v_mfma_f32_16x16x32_bf16 v[212:215], v[20:23], v[28:31], v[212:215]
    buffer_store_dwordx4 v[132:135], v60, s[16:19], s43 offen offset:256 sc0 sc1
    v_cvt_pk_bf16_f32 v192, v192, v193
    v_mfma_f32_16x16x32_bf16 v[220:223], v[20:23], v[32:35], v[220:223]
    v_cvt_pk_bf16_f32 v193, v194, v195
    v_cvt_pk_bf16_f32 v194, v196, v197
    s_waitcnt lgkmcnt(2)
    v_mfma_f32_16x16x32_bf16 v[96:99], v[48:51], v[8:11], v[96:99]
    ds_read_b128 v[20:23], v5 offset:14336
    v_cvt_pk_bf16_f32 v195, v198, v199
    v_mfma_f32_16x16x32_bf16 v[100:103], v[52:55], v[8:11], v[100:103]
    v_cvt_pk_bf16_f32 v196, v200, v201
    v_cvt_pk_bf16_f32 v197, v202, v203
    v_mfma_f32_16x16x32_bf16 v[160:163], v[56:59], v[8:11], v[160:163]
    v_cvt_pk_bf16_f32 v198, v204, v205
    v_cvt_pk_bf16_f32 v199, v206, v207
    v_mfma_f32_16x16x32_bf16 v[164:167], v[24:27], v[8:11], v[164:167]
    buffer_store_dwordx4 v[192:195], v60, s[16:19], s43 offen offset:2048 sc0 sc1
    buffer_store_dwordx4 v[196:199], v60, s[16:19], s43 offen offset:2304 sc0 sc1
    v_mfma_f32_16x16x32_bf16 v[224:227], v[8:11], v[28:31], v[224:227]
    s_add_u32 s43, s43, 4096
    v_mfma_f32_16x16x32_bf16 v[232:235], v[8:11], v[32:35], v[232:235]
    v_cvt_pk_bf16_f32 v144, v144, v145
    v_cvt_pk_bf16_f32 v145, v146, v147
    s_waitcnt lgkmcnt(2)
    v_mfma_f32_16x16x32_bf16 v[104:107], v[48:51], v[12:15], v[104:107]
    v_cvt_pk_bf16_f32 v146, v148, v149
    v_cvt_pk_bf16_f32 v147, v150, v151
    v_mfma_f32_16x16x32_bf16 v[108:111], v[52:55], v[12:15], v[108:111]
    v_cvt_pk_bf16_f32 v148, v152, v153
    v_cvt_pk_bf16_f32 v149, v154, v155
    v_mfma_f32_16x16x32_bf16 v[168:171], v[56:59], v[12:15], v[168:171]
    v_cvt_pk_bf16_f32 v150, v156, v157
    v_cvt_pk_bf16_f32 v151, v158, v159
    v_mfma_f32_16x16x32_bf16 v[172:175], v[24:27], v[12:15], v[172:175]
    buffer_store_dwordx4 v[144:147], v60, s[16:19], s43 offen sc0 sc1
    buffer_store_dwordx4 v[148:151], v60, s[16:19], s43 offen offset:256 sc0 sc1
    v_mfma_f32_16x16x32_bf16 v[228:231], v[12:15], v[28:31], v[228:231]
    v_cvt_pk_bf16_f32 v208, v208, v209
    v_cvt_pk_bf16_f32 v209, v210, v211
    v_mfma_f32_16x16x32_bf16 v[236:239], v[12:15], v[32:35], v[236:239]
    v_cvt_pk_bf16_f32 v210, v212, v213
    v_cvt_pk_bf16_f32 v211, v214, v215
    s_waitcnt lgkmcnt(1)
    v_mfma_f32_16x16x32_bf16 v[180:183], v[24:27], v[16:19], v[180:183]
    v_cvt_pk_bf16_f32 v212, v216, v217
    v_cvt_pk_bf16_f32 v213, v218, v219
    v_mfma_f32_16x16x32_bf16 v[240:243], v[16:19], v[28:31], v[240:243]
    v_cvt_pk_bf16_f32 v214, v220, v221
    v_cvt_pk_bf16_f32 v215, v222, v223
    v_mfma_f32_16x16x32_bf16 v[248:251], v[16:19], v[32:35], v[248:251]
    buffer_store_dwordx4 v[208:211], v60, s[16:19], s43 offen offset:2048 sc0 sc1
    buffer_store_dwordx4 v[212:215], v60, s[16:19], s43 offen offset:2304 sc0 sc1
    s_waitcnt lgkmcnt(0)
    v_mfma_f32_16x16x32_bf16 v[188:191], v[24:27], v[20:23], v[188:191]
    s_add_u32 s43, s43, 4096
    v_mfma_f32_16x16x32_bf16 v[244:247], v[20:23], v[28:31], v[244:247]
    v_mfma_f32_16x16x32_bf16 v[252:255], v[20:23], v[32:35], v[252:255]
    v_cvt_pk_bf16_f32 v160, v160, v161
    v_cvt_pk_bf16_f32 v161, v162, v163
    v_mfma_f32_16x16x32_bf16 v[112:115], v[48:51], v[16:19], v[112:115]
    v_cvt_pk_bf16_f32 v162, v164, v165
    v_cvt_pk_bf16_f32 v163, v166, v167
    v_mfma_f32_16x16x32_bf16 v[116:119], v[52:55], v[16:19], v[116:119]
    v_cvt_pk_bf16_f32 v164, v168, v169
    v_cvt_pk_bf16_f32 v165, v170, v171
    v_mfma_f32_16x16x32_bf16 v[176:179], v[56:59], v[16:19], v[176:179]
    v_cvt_pk_bf16_f32 v166, v172, v173
    v_cvt_pk_bf16_f32 v167, v174, v175
    v_mfma_f32_16x16x32_bf16 v[120:123], v[48:51], v[20:23], v[120:123]
    buffer_store_dwordx4 v[160:163], v60, s[16:19], s43 offen sc0 sc1
    buffer_store_dwordx4 v[164:167], v60, s[16:19], s43 offen offset:256 sc0 sc1
    v_mfma_f32_16x16x32_bf16 v[124:127], v[52:55], v[20:23], v[124:127]
    v_cvt_pk_bf16_f32 v224, v224, v225
    v_cvt_pk_bf16_f32 v225, v226, v227
    v_mfma_f32_16x16x32_bf16 v[184:187], v[56:59], v[20:23], v[184:187]
    v_cvt_pk_bf16_f32 v226, v228, v229
    v_cvt_pk_bf16_f32 v227, v230, v231
    v_cvt_pk_bf16_f32 v228, v232, v233
    v_cvt_pk_bf16_f32 v229, v234, v235
    v_cvt_pk_bf16_f32 v230, v236, v237
    v_cvt_pk_bf16_f32 v231, v238, v239
    buffer_store_dwordx4 v[224:227], v60, s[16:19], s43 offen offset:2048 sc0 sc1
    buffer_store_dwordx4 v[228:231], v60, s[16:19], s43 offen offset:2304 sc0 sc1
    s_add_u32 s43, s43, 4096
    v_cvt_pk_bf16_f32 v176, v176, v177
    v_cvt_pk_bf16_f32 v177, v178, v179
    v_cvt_pk_bf16_f32 v178, v180, v181
    v_cvt_pk_bf16_f32 v179, v182, v183
    v_cvt_pk_bf16_f32 v180, v184, v185
    v_cvt_pk_bf16_f32 v181, v186, v187
    v_cvt_pk_bf16_f32 v182, v188, v189
    v_cvt_pk_bf16_f32 v183, v190, v191
    buffer_store_dwordx4 v[176:179], v60, s[16:19], s43 offen sc0 sc1
    buffer_store_dwordx4 v[180:183], v60, s[16:19], s43 offen offset:256 sc0 sc1
    v_cvt_pk_bf16_f32 v240, v240, v241
    v_cvt_pk_bf16_f32 v241, v242, v243
    v_cvt_pk_bf16_f32 v242, v244, v245
    v_cvt_pk_bf16_f32 v243, v246, v247
    v_cvt_pk_bf16_f32 v244, v248, v249
    v_cvt_pk_bf16_f32 v245, v250, v251
    v_cvt_pk_bf16_f32 v246, v252, v253
    v_cvt_pk_bf16_f32 v247, v254, v255
    buffer_store_dwordx4 v[240:243], v60, s[16:19], s43 offen offset:2048 sc0 sc1
    buffer_store_dwordx4 v[244:247], v60, s[16:19], s43 offen offset:2304 sc0 sc1
    s_barrier
    v_pk_mul_f32 v[64:65], v[64:65], s[44:45]
    v_pk_mul_f32 v[66:67], v[66:67], s[44:45]
    v_pk_mul_f32 v[68:69], v[68:69], s[44:45]
    v_pk_mul_f32 v[70:71], v[70:71], s[44:45]
    v_pk_mul_f32 v[72:73], v[72:73], s[44:45]
    v_pk_mul_f32 v[74:75], v[74:75], s[44:45]
    v_pk_mul_f32 v[76:77], v[76:77], s[44:45]
    v_pk_mul_f32 v[78:79], v[78:79], s[44:45]
    v_cvt_pk_bf16_f32 v64, v64, v65
    v_cvt_pk_bf16_f32 v65, v66, v67
    v_cvt_pk_bf16_f32 v66, v68, v69
    v_cvt_pk_bf16_f32 v67, v70, v71
    v_cvt_pk_bf16_f32 v68, v72, v73
    v_cvt_pk_bf16_f32 v69, v74, v75
    v_cvt_pk_bf16_f32 v70, v76, v77
    v_cvt_pk_bf16_f32 v71, v78, v79
    buffer_store_dwordx4 v[64:67], v60, s[16:19], s41 offen offset:0 sc0 sc1
    buffer_store_dwordx4 v[68:71], v60, s[16:19], s41 offen offset:256 sc0 sc1
    v_pk_mul_f32 v[80:81], v[80:81], s[44:45]
    v_pk_mul_f32 v[82:83], v[82:83], s[44:45]
    v_pk_mul_f32 v[84:85], v[84:85], s[44:45]
    v_pk_mul_f32 v[86:87], v[86:87], s[44:45]
    v_pk_mul_f32 v[88:89], v[88:89], s[44:45]
    v_pk_mul_f32 v[90:91], v[90:91], s[44:45]
    v_pk_mul_f32 v[92:93], v[92:93], s[44:45]
    v_pk_mul_f32 v[94:95], v[94:95], s[44:45]
    v_cvt_pk_bf16_f32 v80, v80, v81
    v_cvt_pk_bf16_f32 v81, v82, v83
    v_cvt_pk_bf16_f32 v82, v84, v85
    v_cvt_pk_bf16_f32 v83, v86, v87
    v_cvt_pk_bf16_f32 v84, v88, v89
    v_cvt_pk_bf16_f32 v85, v90, v91
    v_cvt_pk_bf16_f32 v86, v92, v93
    v_cvt_pk_bf16_f32 v87, v94, v95
    buffer_store_dwordx4 v[80:83], v60, s[16:19], s41 offen offset:2048 sc0 sc1
    buffer_store_dwordx4 v[84:87], v60, s[16:19], s41 offen offset:2304 sc0 sc1
    v_pk_mul_f32 v[96:97], v[96:97], s[44:45]
    v_pk_mul_f32 v[98:99], v[98:99], s[44:45]
    v_pk_mul_f32 v[100:101], v[100:101], s[44:45]
    v_pk_mul_f32 v[102:103], v[102:103], s[44:45]
    v_pk_mul_f32 v[104:105], v[104:105], s[44:45]
    v_pk_mul_f32 v[106:107], v[106:107], s[44:45]
    v_pk_mul_f32 v[108:109], v[108:109], s[44:45]
    v_pk_mul_f32 v[110:111], v[110:111], s[44:45]
    v_cvt_pk_bf16_f32 v96, v96, v97
    v_cvt_pk_bf16_f32 v97, v98, v99
    v_cvt_pk_bf16_f32 v98, v100, v101
    v_cvt_pk_bf16_f32 v99, v102, v103
    v_cvt_pk_bf16_f32 v100, v104, v105
    v_cvt_pk_bf16_f32 v101, v106, v107
    v_cvt_pk_bf16_f32 v102, v108, v109
    v_cvt_pk_bf16_f32 v103, v110, v111
    buffer_store_dwordx4 v[96:99], v60, s[16:19], s42 offen offset:0 sc0 sc1
    buffer_store_dwordx4 v[100:103], v60, s[16:19], s42 offen offset:256 sc0 sc1
    v_pk_mul_f32 v[112:113], v[112:113], s[44:45]
    v_pk_mul_f32 v[114:115], v[114:115], s[44:45]
    v_pk_mul_f32 v[116:117], v[116:117], s[44:45]
    v_pk_mul_f32 v[118:119], v[118:119], s[44:45]
    v_pk_mul_f32 v[120:121], v[120:121], s[44:45]
    v_pk_mul_f32 v[122:123], v[122:123], s[44:45]
    v_pk_mul_f32 v[124:125], v[124:125], s[44:45]
    v_pk_mul_f32 v[126:127], v[126:127], s[44:45]
    v_cvt_pk_bf16_f32 v112, v112, v113
    v_cvt_pk_bf16_f32 v113, v114, v115
    v_cvt_pk_bf16_f32 v114, v116, v117
    v_cvt_pk_bf16_f32 v115, v118, v119
    v_cvt_pk_bf16_f32 v116, v120, v121
    v_cvt_pk_bf16_f32 v117, v122, v123
    v_cvt_pk_bf16_f32 v118, v124, v125
    v_cvt_pk_bf16_f32 v119, v126, v127
    buffer_store_dwordx4 v[112:115], v60, s[16:19], s42 offen offset:2048 sc0 sc1
    buffer_store_dwordx4 v[116:119], v60, s[16:19], s42 offen offset:2304 sc0 sc1
    s_branch L_p1_done
L_p1_epiA:
    s_lshl_b32 s29, s27, 12
    v_add_u32 v62, s29, v60
    s_lshl_b32 s29, s27, 13
    v_add_u32 v61, s29, v60
    s_waitcnt lgkmcnt(8)
    v_mfma_f32_16x16x32_bf16 v[64:67], v[48:51], v[8:11], v[64:67]
    ds_read_b128 v[20:23], v5 offset:6144
    v_mfma_f32_16x16x32_bf16 v[68:71], v[52:55], v[8:11], v[68:71]
    v_mfma_f32_16x16x32_bf16 v[128:131], v[56:59], v[8:11], v[128:131]
    s_waitcnt lgkmcnt(8)
    v_mfma_f32_16x16x32_bf16 v[72:75], v[48:51], v[12:15], v[72:75]
    v_mfma_f32_16x16x32_bf16 v[76:79], v[52:55], v[12:15], v[76:79]
    v_mfma_f32_16x16x32_bf16 v[136:139], v[56:59], v[12:15], v[136:139]
    s_waitcnt lgkmcnt(6)
    v_mfma_f32_16x16x32_bf16 v[132:135], v[24:27], v[8:11], v[132:135]
    s_waitcnt lgkmcnt(4)
    v_mfma_f32_16x16x32_bf16 v[192:195], v[8:11], v[28:31], v[192:195]
    s_waitcnt lgkmcnt(2)
    v_mfma_f32_16x16x32_bf16 v[200:203], v[8:11], v[32:35], v[200:203]
    v_mfma_f32_16x16x32_bf16 v[140:143], v[24:27], v[12:15], v[140:143]
    ds_read_b128 v[8:11], v5 offset:8192
    v_mfma_f32_16x16x32_bf16 v[196:199], v[12:15], v[28:31], v[196:199]
    s_barrier
    v_mfma_f32_16x16x32_bf16 v[204:207], v[12:15], v[32:35], v[204:207]
    s_waitcnt lgkmcnt(2)
    v_mfma_f32_16x16x32_bf16 v[80:83], v[48:51], v[16:19], v[80:83]
    ds_read_b128 v[12:15], v5 offset:10240
    v_mfma_f32_16x16x32_bf16 v[84:87], v[52:55], v[16:19], v[84:87]
    v_mfma_f32_16x16x32_bf16 v[144:147], v[56:59], v[16:19], v[144:147]
    v_mfma_f32_16x16x32_bf16 v[148:151], v[24:27], v[16:19], v[148:151]
    v_mfma_f32_16x16x32_bf16 v[208:211], v[16:19], v[28:31], v[208:211]
    v_mfma_f32_16x16x32_bf16 v[216:219], v[16:19], v[32:35], v[216:219]
    v_cvt_pk_bf16_f32 v128, v128, v129
    v_cvt_pk_bf16_f32 v129, v130, v131
    s_waitcnt lgkmcnt(2)
    v_mfma_f32_16x16x32_bf16 v[88:91], v[48:51], v[20:23], v[88:91]
    ds_read_b128 v[16:19], v5 offset:12288
    v_cvt_pk_bf16_f32 v130, v132, v133
    v_mfma_f32_16x16x32_bf16 v[92:95], v[52:55], v[20:23], v[92:95]
    v_cvt_pk_bf16_f32 v131, v134, v135
    v_cvt_pk_bf16_f32 v132, v136, v137
    v_mfma_f32_16x16x32_bf16 v[152:155], v[56:59], v[20:23], v[152:155]
    v_cvt_pk_bf16_f32 v133, v138, v139
    v_cvt_pk_bf16_f32 v134, v140, v141
    v_mfma_f32_16x16x32_bf16 v[156:159], v[24:27], v[20:23], v[156:159]
    v_cvt_pk_bf16_f32 v135, v142, v143
    ds_write_b128 v62, v[128:131] offset:0
    v_mfma_f32_16x16x32_bf16 v[212:215], v[20:23], v[28:31], v[212:215]
    ds_write_b128 v62, v[132:135] offset:256
    v_cvt_pk_bf16_f32 v192, v192, v193
    v_mfma_f32_16x16x32_bf16 v[220:223], v[20:23], v[32:35], v[220:223]
    v_cvt_pk_bf16_f32 v193, v194, v195
    v_cvt_pk_bf16_f32 v194, v196, v197
    s_waitcnt lgkmcnt(4)
    v_mfma_f32_16x16x32_bf16 v[96:99], v[48:51], v[8:11], v[96:99]
    ds_read_b128 v[20:23], v5 offset:14336
    v_cvt_pk_bf16_f32 v195, v198, v199
    v_mfma_f32_16x16x32_bf16 v[100:103], v[52:55], v[8:11], v[100:103]
    v_cvt_pk_bf16_f32 v196, v200, v201
    v_cvt_pk_bf16_f32 v197, v202, v203
    v_mfma_f32_16x16x32_bf16 v[160:163], v[56:59], v[8:11], v[160:163]
    v_cvt_pk_bf16_f32 v198, v204, v205
    v_cvt_pk_bf16_f32 v199, v206, v207
    v_mfma_f32_16x16x32_bf16 v[164:167], v[24:27], v[8:11], v[164:167]
    v_mfma_f32_16x16x32_bf16 v[224:227], v[8:11], v[28:31], v[224:227]
    v_mfma_f32_16x16x32_bf16 v[232:235], v[8:11], v[32:35], v[232:235]
    v_cvt_pk_bf16_f32 v144, v144, v145
    v_cvt_pk_bf16_f32 v145, v146, v147
    s_waitcnt lgkmcnt(4)
    v_mfma_f32_16x16x32_bf16 v[104:107], v[48:51], v[12:15], v[104:107]
    v_cvt_pk_bf16_f32 v146, v148, v149
    v_cvt_pk_bf16_f32 v147, v150, v151
    v_mfma_f32_16x16x32_bf16 v[108:111], v[52:55], v[12:15], v[108:111]
    v_cvt_pk_bf16_f32 v148, v152, v153
    v_cvt_pk_bf16_f32 v149, v154, v155
    v_mfma_f32_16x16x32_bf16 v[168:171], v[56:59], v[12:15], v[168:171]
    v_cvt_pk_bf16_f32 v150, v156, v157
    v_cvt_pk_bf16_f32 v151, v158, v159
    v_mfma_f32_16x16x32_bf16 v[172:175], v[24:27], v[12:15], v[172:175]
    ds_write_b128 v62, v[144:147] offset:2048
    ds_write_b128 v62, v[148:151] offset:2304
    v_mfma_f32_16x16x32_bf16 v[228:231], v[12:15], v[28:31], v[228:231]
    v_cvt_pk_bf16_f32 v208, v208, v209
    v_cvt_pk_bf16_f32 v209, v210, v211
    v_mfma_f32_16x16x32_bf16 v[236:239], v[12:15], v[32:35], v[236:239]
    v_cvt_pk_bf16_f32 v210, v212, v213
    v_cvt_pk_bf16_f32 v211, v214, v215
    s_waitcnt lgkmcnt(5)
    v_mfma_f32_16x16x32_bf16 v[180:183], v[24:27], v[16:19], v[180:183]
    v_cvt_pk_bf16_f32 v212, v216, v217
    v_cvt_pk_bf16_f32 v213, v218, v219
    v_mfma_f32_16x16x32_bf16 v[240:243], v[16:19], v[28:31], v[240:243]
    v_cvt_pk_bf16_f32 v214, v220, v221
    v_cvt_pk_bf16_f32 v215, v222, v223
    v_mfma_f32_16x16x32_bf16 v[248:251], v[16:19], v[32:35], v[248:251]
    s_waitcnt lgkmcnt(2)
    v_mfma_f32_16x16x32_bf16 v[188:191], v[24:27], v[20:23], v[188:191]
    s_waitcnt lgkmcnt(0)
    s_barrier
    v_mfma_f32_16x16x32_bf16 v[244:247], v[20:23], v[28:31], v[244:247]
    v_mfma_f32_16x16x32_bf16 v[252:255], v[20:23], v[32:35], v[252:255]
    v_cvt_pk_bf16_f32 v160, v160, v161
    v_cvt_pk_bf16_f32 v161, v162, v163
    v_mfma_f32_16x16x32_bf16 v[112:115], v[48:51], v[16:19], v[112:115]
    v_cvt_pk_bf16_f32 v162, v164, v165
    v_cvt_pk_bf16_f32 v163, v166, v167
    v_mfma_f32_16x16x32_bf16 v[116:119], v[52:55], v[16:19], v[116:119]
    v_cvt_pk_bf16_f32 v164, v168, v169
    v_cvt_pk_bf16_f32 v165, v170, v171
    v_mfma_f32_16x16x32_bf16 v[176:179], v[56:59], v[16:19], v[176:179]
    v_cvt_pk_bf16_f32 v166, v172, v173
    v_cvt_pk_bf16_f32 v167, v174, v175
    v_mfma_f32_16x16x32_bf16 v[120:123], v[48:51], v[20:23], v[120:123]
    ds_write_b128 v61, v[160:163] offset:36864
    ds_write_b128 v61, v[164:167] offset:37120
    v_mfma_f32_16x16x32_bf16 v[124:127], v[52:55], v[20:23], v[124:127]
    v_mfma_f32_16x16x32_bf16 v[184:187], v[56:59], v[20:23], v[184:187]
    s_nop 0
    v_cvt_pk_bf16_f32 v176, v176, v177
    v_cvt_pk_bf16_f32 v177, v178, v179
    v_cvt_pk_bf16_f32 v178, v180, v181
    v_cvt_pk_bf16_f32 v179, v182, v183
    s_nop 2
    v_cvt_pk_bf16_f32 v180, v184, v185
    v_cvt_pk_bf16_f32 v181, v186, v187
    v_cvt_pk_bf16_f32 v182, v188, v189
    v_cvt_pk_bf16_f32 v183, v190, v191
    ds_write_b128 v61, v[176:179] offset:38912
    ds_write_b128 v61, v[180:183] offset:39168
    v_add_u32 v5, s29, v1
    ds_read_b128 v[128:131], v5 offset:36864
    ds_read_b128 v[132:135], v5 offset:37888
    ds_read_b128 v[136:139], v5 offset:38912
    ds_read_b128 v[140:143], v5 offset:39936
    s_lshl_b32 s41, s40, 11
    s_add_u32 s41, s41, 12582912
    s_add_u32 s42, s41, 4096
    s_mov_b32 s44, 1069066811
    s_mov_b32 s45, 1069066811
    v_lshrrev_b32 v2, 5, v0
    v_bfe_u32 v3, v0, 2, 2
    v_lshl_add_u32 v3, v2, 2, v3
    v_bfe_u32 v4, v0, 4, 1
    v_lshlrev_b32 v4, 5, v4
    v_and_b32 v7, 3, v0
    v_lshl_add_u32 v4, v7, 3, v4
    v_lshl_add_u32 v7, v3, 6, v4
    s_lshl_b32 s29, s37, 11
    s_add_u32 s29, s29, 159744
    v_add_u32 v7, s29, v7
    ds_read_b64_tr_b16 v[8:9], v7 offset:0
    ds_read_b64_tr_b16 v[10:11], v7 offset:1024
    ds_read_b64_tr_b16 v[12:13], v7 offset:512
    ds_read_b64_tr_b16 v[14:15], v7 offset:1536
    s_and_b32 s46, s27, 3
    s_mul_i32 s46, s46, 17408
    s_add_u32 s46, s46, 65536
    v_and_b32 v6, 31, v0
    v_mul_u32_u24 v6, 136, v6
    v_lshl_add_u32 v6, v2, 3, v6
    v_add_u32 v6, s46, v6
    v_mul_u32_u24 v7, 136, v3
    v_add3_u32 v7, v7, v4, s46
    s_waitcnt lgkmcnt(0)
    v_mfma_f32_32x32x16_bf16 v[144:159], v[8:11], v[128:131], 0
    v_mfma_f32_32x32x16_bf16 v[144:159], v[12:15], v[132:135], v[144:159]
    v_mfma_f32_32x32x16_bf16 v[160:175], v[8:11], v[136:139], 0
    v_mfma_f32_32x32x16_bf16 v[160:175], v[12:15], v[140:143], v[160:175]
    ds_write_b128 v61, v[192:195] offset:32768
    ds_write_b128 v61, v[196:199] offset:33024
    ds_read_b128 v[192:195], v5 offset:32768
    ds_read_b128 v[196:199], v5 offset:33792
    ds_write_b128 v61, v[208:211] offset:34816
    ds_write_b128 v61, v[212:215] offset:35072
    ds_read_b128 v[208:211], v5 offset:34816
    ds_read_b128 v[212:215], v5 offset:35840
    v_cvt_pk_bf16_f32 v224, v224, v225
    v_cvt_pk_bf16_f32 v225, v226, v227
    v_cvt_pk_bf16_f32 v226, v228, v229
    v_cvt_pk_bf16_f32 v227, v230, v231
    v_cvt_pk_bf16_f32 v228, v232, v233
    v_cvt_pk_bf16_f32 v229, v234, v235
    v_cvt_pk_bf16_f32 v230, v236, v237
    v_cvt_pk_bf16_f32 v231, v238, v239
    ds_write_b128 v61, v[224:227] offset:36864
    ds_write_b128 v61, v[228:231] offset:37120
    ds_read_b128 v[224:227], v5 offset:36864
    ds_read_b128 v[228:231], v5 offset:37888
    v_cvt_pk_bf16_f32 v240, v240, v241
    v_cvt_pk_bf16_f32 v241, v242, v243
    v_cvt_pk_bf16_f32 v242, v244, v245
    v_cvt_pk_bf16_f32 v243, v246, v247
    v_cvt_pk_bf16_f32 v244, v248, v249
    v_cvt_pk_bf16_f32 v245, v250, v251
    v_cvt_pk_bf16_f32 v246, v252, v253
    v_cvt_pk_bf16_f32 v247, v254, v255
    ds_write_b128 v61, v[240:243] offset:38912
    ds_write_b128 v61, v[244:247] offset:39168
    ds_read_b128 v[240:243], v5 offset:38912
    ds_read_b128 v[244:247], v5 offset:39936
    v_cvt_pk_bf16_f32 v64, v64, v65
    v_cvt_pk_bf16_f32 v65, v66, v67
    v_cvt_pk_bf16_f32 v66, v68, v69
    v_cvt_pk_bf16_f32 v67, v70, v71
    v_cvt_pk_bf16_f32 v68, v72, v73
    v_cvt_pk_bf16_f32 v69, v74, v75
    v_cvt_pk_bf16_f32 v70, v76, v77
    v_cvt_pk_bf16_f32 v71, v78, v79
    buffer_store_dwordx4 v[64:67], v60, s[16:19], s41 offen offset:0 sc0 sc1
    buffer_store_dwordx4 v[68:71], v60, s[16:19], s41 offen offset:256 sc0 sc1
    v_cvt_pk_bf16_f32 v80, v80, v81
    v_cvt_pk_bf16_f32 v81, v82, v83
    v_cvt_pk_bf16_f32 v82, v84, v85
    v_cvt_pk_bf16_f32 v83, v86, v87
    v_cvt_pk_bf16_f32 v84, v88, v89
    v_cvt_pk_bf16_f32 v85, v90, v91
    v_cvt_pk_bf16_f32 v86, v92, v93
    v_cvt_pk_bf16_f32 v87, v94, v95
    buffer_store_dwordx4 v[80:83], v60, s[16:19], s41 offen offset:2048 sc0 sc1
    buffer_store_dwordx4 v[84:87], v60, s[16:19], s41 offen offset:2304 sc0 sc1
    v_cvt_pk_bf16_f32 v96, v96, v97
    v_cvt_pk_bf16_f32 v97, v98, v99
    v_cvt_pk_bf16_f32 v98, v100, v101
    v_cvt_pk_bf16_f32 v99, v102, v103
    v_cvt_pk_bf16_f32 v100, v104, v105
    v_cvt_pk_bf16_f32 v101, v106, v107
    v_cvt_pk_bf16_f32 v102, v108, v109
    v_cvt_pk_bf16_f32 v103, v110, v111
    buffer_store_dwordx4 v[96:99], v60, s[16:19], s42 offen offset:0 sc0 sc1
    buffer_store_dwordx4 v[100:103], v60, s[16:19], s42 offen offset:256 sc0 sc1
    v_cvt_pk_bf16_f32 v112, v112, v113
    v_cvt_pk_bf16_f32 v113, v114, v115
    v_cvt_pk_bf16_f32 v114, v116, v117
    v_cvt_pk_bf16_f32 v115, v118, v119
    v_cvt_pk_bf16_f32 v116, v120, v121
    v_cvt_pk_bf16_f32 v117, v122, v123
    v_cvt_pk_bf16_f32 v118, v124, v125
    v_cvt_pk_bf16_f32 v119, v126, v127
    buffer_store_dwordx4 v[112:115], v60, s[16:19], s42 offen offset:2048 sc0 sc1
    buffer_store_dwordx4 v[116:119], v60, s[16:19], s42 offen offset:2304 sc0 sc1
    v_max3_f32 v20, v144, v145, v146
    v_min3_f32 v21, v144, v145, v146
    v_max3_f32 v20, v20, v147, v148
    v_min3_f32 v21, v21, v147, v148
    v_max3_f32 v20, v20, v149, v150
    v_min3_f32 v21, v21, v149, v150
    v_max3_f32 v20, v20, v151, v152
    v_min3_f32 v21, v21, v151, v152
    v_max3_f32 v20, v20, v153, v154
    v_min3_f32 v21, v21, v153, v154
    v_max3_f32 v20, v20, v155, v156
    v_min3_f32 v21, v21, v155, v156
    v_max3_f32 v20, v20, v157, v158
    v_min3_f32 v21, v21, v157, v158
    v_max_f32 v20, v20, v159
    v_min_f32 v21, v21, v159
    v_mov_b32 v22, v20
    v_mov_b32 v23, v21
    s_nop 0
    v_permlane32_swap_b32 v20, v22
    v_permlane32_swap_b32 v21, v23
    v_max_f32 v20, v20, v22
    v_min_f32 v21, v21, v23
    v_mul_f32 v24, s44, v20
    v_mul_f32 v26, s44, v21
    v_pk_fma_f32 v[176:177], v[144:145], s[44:45], v[24:25] op_sel_hi:[1,1,0] neg_lo:[0,0,1] neg_hi:[0,0,1]
    v_pk_fma_f32 v[178:179], v[146:147], s[44:45], v[24:25] op_sel_hi:[1,1,0] neg_lo:[0,0,1] neg_hi:[0,0,1]
    v_pk_fma_f32 v[180:181], v[148:149], s[44:45], v[24:25] op_sel_hi:[1,1,0] neg_lo:[0,0,1] neg_hi:[0,0,1]
    v_pk_fma_f32 v[182:183], v[150:151], s[44:45], v[24:25] op_sel_hi:[1,1,0] neg_lo:[0,0,1] neg_hi:[0,0,1]
    v_pk_fma_f32 v[184:185], v[152:153], s[44:45], v[24:25] op_sel_hi:[1,1,0] neg_lo:[0,0,1] neg_hi:[0,0,1]
    v_pk_fma_f32 v[186:187], v[154:155], s[44:45], v[24:25] op_sel_hi:[1,1,0] neg_lo:[0,0,1] neg_hi:[0,0,1]
    v_pk_fma_f32 v[188:189], v[156:157], s[44:45], v[24:25] op_sel_hi:[1,1,0] neg_lo:[0,0,1] neg_hi:[0,0,1]
    v_pk_fma_f32 v[190:191], v[158:159], s[44:45], v[24:25] op_sel_hi:[1,1,0] neg_lo:[0,0,1] neg_hi:[0,0,1]
    v_pk_fma_f32 v[144:145], v[144:145], s[44:45], v[26:27] op_sel_hi:[1,1,0] neg_lo:[1,0,0] neg_hi:[1,0,0]
    v_pk_fma_f32 v[146:147], v[146:147], s[44:45], v[26:27] op_sel_hi:[1,1,0] neg_lo:[1,0,0] neg_hi:[1,0,0]
    v_pk_fma_f32 v[148:149], v[148:149], s[44:45], v[26:27] op_sel_hi:[1,1,0] neg_lo:[1,0,0] neg_hi:[1,0,0]
    v_pk_fma_f32 v[150:151], v[150:151], s[44:45], v[26:27] op_sel_hi:[1,1,0] neg_lo:[1,0,0] neg_hi:[1,0,0]
    v_pk_fma_f32 v[152:153], v[152:153], s[44:45], v[26:27] op_sel_hi:[1,1,0] neg_lo:[1,0,0] neg_hi:[1,0,0]
    v_pk_fma_f32 v[154:155], v[154:155], s[44:45], v[26:27] op_sel_hi:[1,1,0] neg_lo:[1,0,0] neg_hi:[1,0,0]
    v_pk_fma_f32 v[156:157], v[156:157], s[44:45], v[26:27] op_sel_hi:[1,1,0] neg_lo:[1,0,0] neg_hi:[1,0,0]
    v_pk_fma_f32 v[158:159], v[158:159], s[44:45], v[26:27] op_sel_hi:[1,1,0] neg_lo:[1,0,0] neg_hi:[1,0,0]
    v_exp_f32 v176, v176
    v_exp_f32 v177, v177
    v_exp_f32 v178, v178
    v_exp_f32 v179, v179
    v_exp_f32 v180, v180
    v_exp_f32 v181, v181
    v_exp_f32 v182, v182
    v_exp_f32 v183, v183
    v_exp_f32 v184, v184
    v_exp_f32 v185, v185
    v_exp_f32 v186, v186
    v_exp_f32 v187, v187
    v_exp_f32 v188, v188
    v_exp_f32 v189, v189
    v_exp_f32 v190, v190
    v_exp_f32 v191, v191
    v_exp_f32 v144, v144
    v_exp_f32 v145, v145
    v_exp_f32 v146, v146
    v_exp_f32 v147, v147
    v_exp_f32 v148, v148
    v_exp_f32 v149, v149
    v_exp_f32 v150, v150
    v_exp_f32 v151, v151
    v_exp_f32 v152, v152
    v_exp_f32 v153, v153
    v_exp_f32 v154, v154
    v_exp_f32 v155, v155
    v_exp_f32 v156, v156
    v_exp_f32 v157, v157
    v_exp_f32 v158, v158
    v_exp_f32 v159, v159
    v_pk_add_f32 v[28:29], v[176:177], v[178:179]
    v_pk_add_f32 v[30:31], v[144:145], v[146:147]
    v_pk_add_f32 v[28:29], v[28:29], v[180:181]
    v_pk_add_f32 v[30:31], v[30:31], v[148:149]
    v_pk_add_f32 v[28:29], v[28:29], v[182:183]
    v_pk_add_f32 v[30:31], v[30:31], v[150:151]
    v_pk_add_f32 v[28:29], v[28:29], v[184:185]
    v_pk_add_f32 v[30:31], v[30:31], v[152:153]
    v_pk_add_f32 v[28:29], v[28:29], v[186:187]
    v_pk_add_f32 v[30:31], v[30:31], v[154:155]
    v_pk_add_f32 v[28:29], v[28:29], v[188:189]
    v_pk_add_f32 v[30:31], v[30:31], v[156:157]
    v_pk_add_f32 v[28:29], v[28:29], v[190:191]
    v_pk_add_f32 v[30:31], v[30:31], v[158:159]
    v_add_f32 v28, v28, v29
    v_add_f32 v30, v30, v31
    v_mov_b32 v22, v28
    v_mov_b32 v23, v30
    s_nop 0
    v_permlane32_swap_b32 v28, v22
    v_permlane32_swap_b32 v30, v23
    v_add_f32 v28, v28, v22
    v_add_f32 v30, v30, v23
    v_rcp_f32 v28, v28
    v_rcp_f32 v30, v30
    v_pk_mul_f32 v[176:177], v[176:177], v[28:29] op_sel_hi:[1,0]
    v_pk_mul_f32 v[178:179], v[178:179], v[28:29] op_sel_hi:[1,0]
    v_pk_mul_f32 v[180:181], v[180:181], v[28:29] op_sel_hi:[1,0]
    v_pk_mul_f32 v[182:183], v[182:183], v[28:29] op_sel_hi:[1,0]
    v_pk_mul_f32 v[184:185], v[184:185], v[28:29] op_sel_hi:[1,0]
    v_pk_mul_f32 v[186:187], v[186:187], v[28:29] op_sel_hi:[1,0]
    v_pk_mul_f32 v[188:189], v[188:189], v[28:29] op_sel_hi:[1,0]
    v_pk_mul_f32 v[190:191], v[190:191], v[28:29] op_sel_hi:[1,0]
    v_pk_mul_f32 v[144:145], v[144:145], v[30:31] op_sel_hi:[1,0]
    v_pk_mul_f32 v[146:147], v[146:147], v[30:31] op_sel_hi:[1,0]
    v_pk_mul_f32 v[148:149], v[148:149], v[30:31] op_sel_hi:[1,0]
    v_pk_mul_f32 v[150:151], v[150:151], v[30:31] op_sel_hi:[1,0]
    v_pk_mul_f32 v[152:153], v[152:153], v[30:31] op_sel_hi:[1,0]
    v_pk_mul_f32 v[154:155], v[154:155], v[30:31] op_sel_hi:[1,0]
    v_pk_mul_f32 v[156:157], v[156:157], v[30:31] op_sel_hi:[1,0]
    v_pk_mul_f32 v[158:159], v[158:159], v[30:31] op_sel_hi:[1,0]
    v_cvt_pk_bf16_f32 v176, v176, v177
    v_cvt_pk_bf16_f32 v177, v178, v179
    v_cvt_pk_bf16_f32 v178, v180, v181
    v_cvt_pk_bf16_f32 v179, v182, v183
    v_cvt_pk_bf16_f32 v180, v184, v185
    v_cvt_pk_bf16_f32 v181, v186, v187
    v_cvt_pk_bf16_f32 v182, v188, v189
    v_cvt_pk_bf16_f32 v183, v190, v191
    v_cvt_pk_bf16_f32 v144, v144, v145
    v_cvt_pk_bf16_f32 v145, v146, v147
    v_cvt_pk_bf16_f32 v146, v148, v149
    v_cvt_pk_bf16_f32 v147, v150, v151
    v_cvt_pk_bf16_f32 v148, v152, v153
    v_cvt_pk_bf16_f32 v149, v154, v155
    v_cvt_pk_bf16_f32 v150, v156, v157
    v_cvt_pk_bf16_f32 v151, v158, v159
    ds_write_b64 v6, v[176:177] offset:8704
    ds_write_b64 v6, v[178:179] offset:8720
    ds_write_b64 v6, v[180:181] offset:8736
    ds_write_b64 v6, v[182:183] offset:8752
    ds_write_b64 v6, v[144:145] offset:8768
    ds_write_b64 v6, v[146:147] offset:8784
    ds_write_b64 v6, v[148:149] offset:8800
    ds_write_b64 v6, v[150:151] offset:8816
    v_max3_f32 v20, v160, v161, v162
    v_min3_f32 v21, v160, v161, v162
    v_max3_f32 v20, v20, v163, v164
    v_min3_f32 v21, v21, v163, v164
    v_max3_f32 v20, v20, v165, v166
    v_min3_f32 v21, v21, v165, v166
    v_max3_f32 v20, v20, v167, v168
    v_min3_f32 v21, v21, v167, v168
    v_max3_f32 v20, v20, v169, v170
    v_min3_f32 v21, v21, v169, v170
    v_max3_f32 v20, v20, v171, v172
    v_min3_f32 v21, v21, v171, v172
    v_max3_f32 v20, v20, v173, v174
    v_min3_f32 v21, v21, v173, v174
    v_max_f32 v20, v20, v175
    v_min_f32 v21, v21, v175
    v_mov_b32 v22, v20
    v_mov_b32 v23, v21
    s_nop 0
    v_permlane32_swap_b32 v20, v22
    v_permlane32_swap_b32 v21, v23
    v_max_f32 v20, v20, v22
    v_min_f32 v21, v21, v23
    v_mul_f32 v24, s44, v20
    v_mul_f32 v26, s44, v21
    v_pk_fma_f32 v[80:81], v[160:161], s[44:45], v[24:25] op_sel_hi:[1,1,0] neg_lo:[0,0,1] neg_hi:[0,0,1]
    v_pk_fma_f32 v[82:83], v[162:163], s[44:45], v[24:25] op_sel_hi:[1,1,0] neg_lo:[0,0,1] neg_hi:[0,0,1]
    v_pk_fma_f32 v[84:85], v[164:165], s[44:45], v[24:25] op_sel_hi:[1,1,0] neg_lo:[0,0,1] neg_hi:[0,0,1]
    v_pk_fma_f32 v[86:87], v[166:167], s[44:45], v[24:25] op_sel_hi:[1,1,0] neg_lo:[0,0,1] neg_hi:[0,0,1]
    v_pk_fma_f32 v[88:89], v[168:169], s[44:45], v[24:25] op_sel_hi:[1,1,0] neg_lo:[0,0,1] neg_hi:[0,0,1]
    v_pk_fma_f32 v[90:91], v[170:171], s[44:45], v[24:25] op_sel_hi:[1,1,0] neg_lo:[0,0,1] neg_hi:[0,0,1]
    v_pk_fma_f32 v[92:93], v[172:173], s[44:45], v[24:25] op_sel_hi:[1,1,0] neg_lo:[0,0,1] neg_hi:[0,0,1]
    v_pk_fma_f32 v[94:95], v[174:175], s[44:45], v[24:25] op_sel_hi:[1,1,0] neg_lo:[0,0,1] neg_hi:[0,0,1]
    v_pk_fma_f32 v[160:161], v[160:161], s[44:45], v[26:27] op_sel_hi:[1,1,0] neg_lo:[1,0,0] neg_hi:[1,0,0]
    v_pk_fma_f32 v[162:163], v[162:163], s[44:45], v[26:27] op_sel_hi:[1,1,0] neg_lo:[1,0,0] neg_hi:[1,0,0]
    v_pk_fma_f32 v[164:165], v[164:165], s[44:45], v[26:27] op_sel_hi:[1,1,0] neg_lo:[1,0,0] neg_hi:[1,0,0]
    v_pk_fma_f32 v[166:167], v[166:167], s[44:45], v[26:27] op_sel_hi:[1,1,0] neg_lo:[1,0,0] neg_hi:[1,0,0]
    v_pk_fma_f32 v[168:169], v[168:169], s[44:45], v[26:27] op_sel_hi:[1,1,0] neg_lo:[1,0,0] neg_hi:[1,0,0]
    v_pk_fma_f32 v[170:171], v[170:171], s[44:45], v[26:27] op_sel_hi:[1,1,0] neg_lo:[1,0,0] neg_hi:[1,0,0]
    v_pk_fma_f32 v[172:173], v[172:173], s[44:45], v[26:27] op_sel_hi:[1,1,0] neg_lo:[1,0,0] neg_hi:[1,0,0]
    v_pk_fma_f32 v[174:175], v[174:175], s[44:45], v[26:27] op_sel_hi:[1,1,0] neg_lo:[1,0,0] neg_hi:[1,0,0]
    v_exp_f32 v80, v80
    v_exp_f32 v81, v81
    v_exp_f32 v82, v82
    v_exp_f32 v83, v83
    v_exp_f32 v84, v84
    v_exp_f32 v85, v85
    v_exp_f32 v86, v86
    v_exp_f32 v87, v87
    v_exp_f32 v88, v88
    v_exp_f32 v89, v89
    v_exp_f32 v90, v90
    v_exp_f32 v91, v91
    v_exp_f32 v92, v92
    v_exp_f32 v93, v93
    v_exp_f32 v94, v94
    v_exp_f32 v95, v95
    v_exp_f32 v160, v160
    v_exp_f32 v161, v161
    v_exp_f32 v162, v162
    v_exp_f32 v163, v163
    v_exp_f32 v164, v164
    v_exp_f32 v165, v165
    v_exp_f32 v166, v166
    v_exp_f32 v167, v167
    v_exp_f32 v168, v168
    v_exp_f32 v169, v169
    v_exp_f32 v170, v170
    v_exp_f32 v171, v171
    v_exp_f32 v172, v172
    v_exp_f32 v173, v173
    v_exp_f32 v174, v174
    v_exp_f32 v175, v175
    v_pk_add_f32 v[28:29], v[80:81], v[82:83]
    v_pk_add_f32 v[30:31], v[160:161], v[162:163]
    v_pk_add_f32 v[28:29], v[28:29], v[84:85]
    v_pk_add_f32 v[30:31], v[30:31], v[164:165]
    v_pk_add_f32 v[28:29], v[28:29], v[86:87]
    v_pk_add_f32 v[30:31], v[30:31], v[166:167]
    v_pk_add_f32 v[28:29], v[28:29], v[88:89]
    v_pk_add_f32 v[30:31], v[30:31], v[168:169]
    v_pk_add_f32 v[28:29], v[28:29], v[90:91]
    v_pk_add_f32 v[30:31], v[30:31], v[170:171]
    v_pk_add_f32 v[28:29], v[28:29], v[92:93]
    v_pk_add_f32 v[30:31], v[30:31], v[172:173]
    v_pk_add_f32 v[28:29], v[28:29], v[94:95]
    v_pk_add_f32 v[30:31], v[30:31], v[174:175]
    v_add_f32 v28, v28, v29
    v_add_f32 v30, v30, v31
    v_mov_b32 v22, v28
    v_mov_b32 v23, v30
    s_nop 0
    v_permlane32_swap_b32 v28, v22
    v_permlane32_swap_b32 v30, v23
    v_add_f32 v28, v28, v22
    v_add_f32 v30, v30, v23
    v_rcp_f32 v28, v28
    v_rcp_f32 v30, v30
    v_pk_mul_f32 v[80:81], v[80:81], v[28:29] op_sel_hi:[1,0]
    v_pk_mul_f32 v[82:83], v[82:83], v[28:29] op_sel_hi:[1,0]
    v_pk_mul_f32 v[84:85], v[84:85], v[28:29] op_sel_hi:[1,0]
    v_pk_mul_f32 v[86:87], v[86:87], v[28:29] op_sel_hi:[1,0]
    v_pk_mul_f32 v[88:89], v[88:89], v[28:29] op_sel_hi:[1,0]
    v_pk_mul_f32 v[90:91], v[90:91], v[28:29] op_sel_hi:[1,0]
    v_pk_mul_f32 v[92:93], v[92:93], v[28:29] op_sel_hi:[1,0]
    v_pk_mul_f32 v[94:95], v[94:95], v[28:29] op_sel_hi:[1,0]
    v_pk_mul_f32 v[160:161], v[160:161], v[30:31] op_sel_hi:[1,0]
    v_pk_mul_f32 v[162:163], v[162:163], v[30:31] op_sel_hi:[1,0]
    v_pk_mul_f32 v[164:165], v[164:165], v[30:31] op_sel_hi:[1,0]
    v_pk_mul_f32 v[166:167], v[166:167], v[30:31] op_sel_hi:[1,0]
    v_pk_mul_f32 v[168:169], v[168:169], v[30:31] op_sel_hi:[1,0]
    v_pk_mul_f32 v[170:171], v[170:171], v[30:31] op_sel_hi:[1,0]
    v_pk_mul_f32 v[172:173], v[172:173], v[30:31] op_sel_hi:[1,0]
    v_pk_mul_f32 v[174:175], v[174:175], v[30:31] op_sel_hi:[1,0]
    v_cvt_pk_bf16_f32 v80, v80, v81
    v_cvt_pk_bf16_f32 v81, v82, v83
    v_cvt_pk_bf16_f32 v82, v84, v85
    v_cvt_pk_bf16_f32 v83, v86, v87
    v_cvt_pk_bf16_f32 v84, v88, v89
    v_cvt_pk_bf16_f32 v85, v90, v91
    v_cvt_pk_bf16_f32 v86, v92, v93
    v_cvt_pk_bf16_f32 v87, v94, v95
    v_cvt_pk_bf16_f32 v160, v160, v161
    v_cvt_pk_bf16_f32 v161, v162, v163
    v_cvt_pk_bf16_f32 v162, v164, v165
    v_cvt_pk_bf16_f32 v163, v166, v167
    v_cvt_pk_bf16_f32 v164, v168, v169
    v_cvt_pk_bf16_f32 v165, v170, v171
    v_cvt_pk_bf16_f32 v166, v172, v173
    v_cvt_pk_bf16_f32 v167, v174, v175
    ds_write_b64 v6, v[80:81] offset:13056
    ds_write_b64 v6, v[82:83] offset:13072
    ds_write_b64 v6, v[84:85] offset:13088
    ds_write_b64 v6, v[86:87] offset:13104
    ds_write_b64 v6, v[160:161] offset:13120
    ds_write_b64 v6, v[162:163] offset:13136
    ds_write_b64 v6, v[164:165] offset:13152
    ds_write_b64 v6, v[166:167] offset:13168
    v_lshrrev_b32 v2, 4, v0
    v_lshrrev_b32 v3, 3, v0
    v_xor_b32 v2, v2, v3
    v_and_b32 v2, 1, v2
    v_cmp_eq_u32 vcc, 0, v2
    v_mov_b32 v3, 0x3f803f80
    v_mov_b32 v2, 0
    v_cndmask_b32 v16, v2, v3, vcc
    v_mov_b32 v17, v16
    v_mov_b32 v18, v16
    v_mov_b32 v19, v16
    s_lshl_b32 s29, s36, 6
    v_add_u32 v7, s29, v7
    s_cmp_eq_u32 s36, 0
    s_mov_b32 s29, 34816
    s_cselect_b32 s29, s29, 4294932480
    v_add_u32 v3, s29, v7
    v_xor_b32 v5, 16384, v5
    s_lshl_b32 s47, s38, 3
    s_add_u32 s47, s47, s25
    s_lshl_b32 s48, s47, 13
    s_lshl_b32 s29, s36, 12
    s_add_u32 s48, s48, s29
    s_add_u32 s48, s48, 16777216
    s_lshl_b32 s49, s47, 8
    s_lshl_b32 s29, s36, 7
    s_add_u32 s49, s49, s29
    s_add_u32 s49, s49, 18874368
    v_bfe_u32 v4, v0, 3, 1
    v_lshlrev_b32 v4, 6, v4
    v_lshrrev_b32 v2, 4, v0
    v_lshl_add_u32 v4, v2, 4, v4
    s_waitcnt lgkmcnt(0)
    s_barrier
    ds_read_b64_tr_b16 v[32:33], v7 offset:0
    ds_read_b64_tr_b16 v[34:35], v7 offset:2176
    ds_read_b64_tr_b16 v[36:37], v7 offset:1088
    ds_read_b64_tr_b16 v[38:39], v7 offset:3264
    ds_read_b64_tr_b16 v[40:41], v7 offset:4352
    ds_read_b64_tr_b16 v[42:43], v7 offset:6528
    ds_read_b64_tr_b16 v[44:45], v7 offset:5440
    ds_read_b64_tr_b16 v[46:47], v7 offset:7616
    ds_read_b128 v[200:203], v5 offset:32768
    ds_read_b128 v[204:207], v5 offset:33792
    ds_read_b64_tr_b16 v[48:49], v7 offset:8704
    ds_read_b64_tr_b16 v[50:51], v7 offset:10880
    ds_read_b64_tr_b16 v[52:53], v7 offset:9792
    ds_read_b64_tr_b16 v[54:55], v7 offset:11968
    s_waitcnt lgkmcnt(10)
    v_mfma_f32_32x32x16_bf16 v[64:79], v[32:35], v[192:195], 0
    v_mfma_f32_16x16x32_bf16 v[128:131], v[32:35], v[16:19], 0
    v_mfma_f32_32x32x16_bf16 v[64:79], v[36:39], v[196:199], v[64:79]
    v_mfma_f32_16x16x32_bf16 v[128:131], v[36:39], v[16:19], v[128:131]
    ds_read_b128 v[216:219], v5 offset:34816
    ds_read_b128 v[220:223], v5 offset:35840
    ds_read_b64_tr_b16 v[32:33], v7 offset:13056
    ds_read_b64_tr_b16 v[34:35], v7 offset:15232
    ds_read_b64_tr_b16 v[36:37], v7 offset:14144
    ds_read_b64_tr_b16 v[38:39], v7 offset:16320
    s_waitcnt lgkmcnt(12)
    v_mfma_f32_32x32x16_bf16 v[64:79], v[40:43], v[208:211], v[64:79]
    v_mfma_f32_16x16x32_bf16 v[128:131], v[40:43], v[16:19], v[128:131]
    v_mfma_f32_32x32x16_bf16 v[64:79], v[44:47], v[212:215], v[64:79]
    v_mfma_f32_16x16x32_bf16 v[128:131], v[44:47], v[16:19], v[128:131]
    ds_read_b128 v[232:235], v5 offset:36864
    ds_read_b128 v[236:239], v5 offset:37888
    ds_read_b64_tr_b16 v[40:41], v3 offset:0
    ds_read_b64_tr_b16 v[42:43], v3 offset:2176
    ds_read_b64_tr_b16 v[44:45], v3 offset:1088
    ds_read_b64_tr_b16 v[46:47], v3 offset:3264
    s_waitcnt lgkmcnt(12)
    v_mfma_f32_32x32x16_bf16 v[64:79], v[48:51], v[224:227], v[64:79]
    v_mfma_f32_16x16x32_bf16 v[128:131], v[48:51], v[16:19], v[128:131]
    v_mfma_f32_32x32x16_bf16 v[64:79], v[52:55], v[228:231], v[64:79]
    v_mfma_f32_16x16x32_bf16 v[128:131], v[52:55], v[16:19], v[128:131]
    ds_read_b128 v[248:251], v5 offset:38912
    ds_read_b128 v[252:255], v5 offset:39936
    ds_read_b64_tr_b16 v[48:49], v3 offset:4352
    ds_read_b64_tr_b16 v[50:51], v3 offset:6528
    ds_read_b64_tr_b16 v[52:53], v3 offset:5440
    ds_read_b64_tr_b16 v[54:55], v3 offset:7616
    s_waitcnt lgkmcnt(12)
    v_mfma_f32_32x32x16_bf16 v[64:79], v[32:35], v[240:243], v[64:79]
    v_mfma_f32_16x16x32_bf16 v[128:131], v[32:35], v[16:19], v[128:131]
    v_mfma_f32_32x32x16_bf16 v[64:79], v[36:39], v[244:247], v[64:79]
    v_mfma_f32_16x16x32_bf16 v[128:131], v[36:39], v[16:19], v[128:131]
    ds_read_b64_tr_b16 v[32:33], v3 offset:8704
    ds_read_b64_tr_b16 v[34:35], v3 offset:10880
    ds_read_b64_tr_b16 v[36:37], v3 offset:9792
    ds_read_b64_tr_b16 v[38:39], v3 offset:11968
    s_waitcnt lgkmcnt(10)
    v_mfma_f32_32x32x16_bf16 v[64:79], v[40:43], v[200:203], v[64:79]
    v_mfma_f32_16x16x32_bf16 v[128:131], v[40:43], v[16:19], v[128:131]
    v_mfma_f32_32x32x16_bf16 v[64:79], v[44:47], v[204:207], v[64:79]
    v_mfma_f32_16x16x32_bf16 v[128:131], v[44:47], v[16:19], v[128:131]
    ds_read_b64_tr_b16 v[40:41], v3 offset:13056
    ds_read_b64_tr_b16 v[42:43], v3 offset:15232
    ds_read_b64_tr_b16 v[44:45], v3 offset:14144
    ds_read_b64_tr_b16 v[46:47], v3 offset:16320
    s_waitcnt lgkmcnt(8)
    v_mfma_f32_32x32x16_bf16 v[64:79], v[48:51], v[216:219], v[64:79]
    v_mfma_f32_16x16x32_bf16 v[128:131], v[48:51], v[16:19], v[128:131]
    v_mfma_f32_32x32x16_bf16 v[64:79], v[52:55], v[220:223], v[64:79]
    v_mfma_f32_16x16x32_bf16 v[128:131], v[52:55], v[16:19], v[128:131]
    s_waitcnt lgkmcnt(4)
    v_mfma_f32_32x32x16_bf16 v[64:79], v[32:35], v[232:235], v[64:79]
    v_mfma_f32_16x16x32_bf16 v[128:131], v[32:35], v[16:19], v[128:131]
    v_mfma_f32_32x32x16_bf16 v[64:79], v[36:39], v[236:239], v[64:79]
    v_mfma_f32_16x16x32_bf16 v[128:131], v[36:39], v[16:19], v[128:131]
    s_waitcnt lgkmcnt(0)
    v_mfma_f32_32x32x16_bf16 v[64:79], v[40:43], v[248:251], v[64:79]
    v_mfma_f32_16x16x32_bf16 v[128:131], v[40:43], v[16:19], v[128:131]
    v_mfma_f32_32x32x16_bf16 v[64:79], v[44:47], v[252:255], v[64:79]
    v_mfma_f32_16x16x32_bf16 v[128:131], v[44:47], v[16:19], v[128:131]
    s_nop 10
    buffer_store_dwordx4 v[64:67], v1, s[16:19], s48 offen offset:0 sc0 sc1
    buffer_store_dwordx4 v[68:71], v1, s[16:19], s48 offen offset:1024 sc0 sc1
    buffer_store_dwordx4 v[72:75], v1, s[16:19], s48 offen offset:2048 sc0 sc1
    buffer_store_dwordx4 v[76:79], v1, s[16:19], s48 offen offset:3072 sc0 sc1
    buffer_store_dwordx4 v[128:131], v4, s[16:19], s49 offen sc0 sc1
L_p1_done:
    s_lshl_b32 s34, s26, 1
    s_add_u32 s34, s34, 1
    s_sub_u32 s34, s34, s24
    s_and_b32 s31, s27, 3
    s_lshl_b32 s35, s25, 3
    s_lshl_b32 s29, s31, 1
    s_add_u32 s35, s35, s29
    s_mul_i32 s40, s34, 268288
    s_add_u32 s40, s40, 33554432
    v_lshlrev_b32 v1, 4, v0
    s_lshl_b32 s47, s35, 5
    s_add_u32 s47, s47, s34
    s_lshl_b32 s47, s47, 11
    s_add_u32 s47, s47, 25165824
    s_waitcnt lgkmcnt(0)
    v_mov_b32 v4, 0xdddd
    v_and_b32 v2, 4, v0
    v_cmp_eq_u32 vcc, 0, v2
    v_mov_b32 v2, 0
    v_mov_b32 v3, 0x3f803f80
    v_cndmask_b32 v8, v2, v3, vcc
    v_cndmask_b32 v10, v3, v2, vcc
    v_mov_b32 v9, v8
    v_mov_b32 v11, v10
    v_mov_b32 v2, v1
    v_and_b32 v22, 0x23, v0
    v_and_b32 v20, 4, v0
    v_lshl_or_b32 v22, v20, 2, v22
    v_and_b32 v20, 0x18, v0
    v_lshrrev_b32 v20, 1, v20
    v_or_b32 v22, v22, v20
    v_lshlrev_b32 v22, 4, v22
    v_mov_b32 v20, v22
    v_xor_b32 v23, v22, v1
    s_lshl_b32 s29, s31, 12
    s_add_u32 s29, s29, 139264
    v_add_u32 v5, s29, v1
    s_lshl_b32 s49, s26, 10
    s_lshl_b32 s29, s25, 7
    s_add_u32 s49, s49, s29
    s_lshl_b32 s29, s36, 3
    s_add_u32 s49, s49, s29
    s_add_u32 s49, s49, 30441472
    s_lshl_b32 s48, s26, 7
    s_lshl_b32 s29, s25, 2
    s_add_u32 s48, s48, s29
    s_add_u32 s48, s48, 30410752
    s_cmp_eq_u32 s24, 0
    s_cselect_b32 s49, s48, s49
    s_cselect_b32 s90, 1, s91
    s_mov_b32 s91, 0
    s_barrier
    ds_read_b128 v[24:27], v5 offset:0
    ds_read_b128 v[28:31], v5 offset:1024
    ds_read_b128 v[32:35], v5 offset:2048
    ds_read_b128 v[36:39], v5 offset:3072
    ds_read_b128 v[40:43], v20 offset:0
    ds_read_b128 v[44:47], v20 offset:1024
    ds_read_b128 v[56:59], v2 offset:2048
    ds_read_b128 v[60:63], v2 offset:3072
    ds_read_b128 v[48:51], v20 offset:4096
    ds_read_b128 v[52:55], v20 offset:5120
    v_pk_mov_b32 v[136:137], 0, 0
    v_pk_mov_b32 v[138:139], 0, 0
    v_pk_mov_b32 v[140:141], 0, 0
    v_pk_mov_b32 v[142:143], 0, 0
    v_pk_mov_b32 v[144:145], 0, 0
    v_pk_mov_b32 v[146:147], 0, 0
    v_pk_mov_b32 v[148:149], 0, 0
    v_pk_mov_b32 v[150:151], 0, 0
    v_pk_mov_b32 v[152:153], 0, 0
    v_pk_mov_b32 v[154:155], 0, 0
    v_pk_mov_b32 v[156:157], 0, 0
    v_pk_mov_b32 v[158:159], 0, 0
    v_pk_mov_b32 v[160:161], 0, 0
    v_pk_mov_b32 v[162:163], 0, 0
    v_pk_mov_b32 v[164:165], 0, 0
    v_pk_mov_b32 v[166:167], 0, 0
    v_pk_mov_b32 v[12:13], 0, 0
    v_pk_mov_b32 v[14:15], 0, 0
    v_pk_mov_b32 v[16:17], 0, 0
    v_pk_mov_b32 v[18:19], 0, 0
    v_pk_mov_b32 v[68:69], 0, 0
    v_pk_mov_b32 v[70:71], 0, 0
    s_cmp_lg_u32 s90, 3
    s_cbranch_scc1 L_p2_pubskip
    s_waitcnt vmcnt(0)
    v_mov_b32 v6, 1
    v_lshlrev_b32 v7, 2, v0
    s_mov_b64 exec, 3
    buffer_atomic_add v6, v7, s[16:19], s49 offen sc1
    s_mov_b64 exec, -1
    s_mov_b32 s90, 0
L_p2_pubskip:
    s_waitcnt lgkmcnt(4)
    v_mfma_f32_32x32x16_bf16 v[104:119], v[40:43], v[24:27], 0
    v_mfma_f32_32x32x16_bf16 v[104:119], v[44:47], v[28:31], v[104:119]
    v_mfma_f32_32x32x16_bf16 v[120:135], v[40:43], v[32:35], 0
    v_mfma_f32_32x32x16_bf16 v[120:135], v[44:47], v[36:39], v[120:135]
    s_nop 9
    v_max3_f32 v6, v104, v105, v106
    v_max3_f32 v6, v6, v107, v108
    v_max3_f32 v6, v6, v109, v110
    v_max3_f32 v6, v6, v111, v112
    v_max3_f32 v6, v6, v113, v114
    v_max3_f32 v6, v6, v115, v116
    v_max3_f32 v6, v6, v117, v118
    v_max_f32 v6, v6, v119
    v_mov_b32 v7, v6
    s_nop 1
    v_permlane32_swap_b32 v6, v7
    v_max_f32 v6, v6, v7
    v_sub_f32 v6, 0, v6
    v_pk_mov_b32 v[72:73], v[6:7], v[6:7] op_sel:[0,0]
    v_pk_mov_b32 v[74:75], v[6:7], v[6:7] op_sel:[0,0]
    v_pk_mov_b32 v[76:77], v[6:7], v[6:7] op_sel:[0,0]
    v_pk_mov_b32 v[78:79], v[6:7], v[6:7] op_sel:[0,0]
    v_pk_mov_b32 v[80:81], v[6:7], v[6:7] op_sel:[0,0]
    v_pk_mov_b32 v[82:83], v[6:7], v[6:7] op_sel:[0,0]
    v_pk_mov_b32 v[84:85], v[6:7], v[6:7] op_sel:[0,0]
    v_pk_mov_b32 v[86:87], v[6:7], v[6:7] op_sel:[0,0]
    s_nop 1
    v_mfma_f32_32x32x16_bf16 v[104:119], v[40:43], v[24:27], v[72:87]
    v_mfma_f32_32x32x16_bf16 v[104:119], v[44:47], v[28:31], v[104:119]
    v_max3_f32 v6, v120, v121, v122
    v_max3_f32 v6, v6, v123, v124
    v_max3_f32 v6, v6, v125, v126
    v_max3_f32 v6, v6, v127, v128
    v_max3_f32 v6, v6, v129, v130
    v_max3_f32 v6, v6, v131, v132
    v_max3_f32 v6, v6, v133, v134
    v_max_f32 v6, v6, v135
    v_mov_b32 v7, v6
    s_nop 1
    v_permlane32_swap_b32 v6, v7
    v_max_f32 v6, v6, v7
    v_sub_f32 v6, 0, v6
    v_pk_mov_b32 v[88:89], v[6:7], v[6:7] op_sel:[0,0]
    v_pk_mov_b32 v[90:91], v[6:7], v[6:7] op_sel:[0,0]
    v_pk_mov_b32 v[92:93], v[6:7], v[6:7] op_sel:[0,0]
    v_pk_mov_b32 v[94:95], v[6:7], v[6:7] op_sel:[0,0]
    v_pk_mov_b32 v[96:97], v[6:7], v[6:7] op_sel:[0,0]
    v_pk_mov_b32 v[98:99], v[6:7], v[6:7] op_sel:[0,0]
    v_pk_mov_b32 v[100:101], v[6:7], v[6:7] op_sel:[0,0]
    v_pk_mov_b32 v[102:103], v[6:7], v[6:7] op_sel:[0,0]
    v_pk_mov_b32 v[128:129], 0, 0
    v_pk_mov_b32 v[130:131], 0, 0
    v_pk_mov_b32 v[132:133], 0, 0
    v_pk_mov_b32 v[134:135], 0, 0
    s_mov_b32 s28, 0
    s_mov_b64 vcc, s[90:91]
.p2align 6
L_p2_loop:
    v_exp_f32 v104, v104
    v_smfmac_f32_32x32x32_bf16 v[152:167], v[68:71], v[128:135], v4
    v_exp_f32 v105, v105
    v_exp_f32 v106, v106
    v_exp_f32 v107, v107
    v_smfmac_f32_16x16x64_bf16 v[16:19], v[8:11], v[128:135], v4
    ds_read_b128 v[64:67], v2 offset:6144
    v_exp_f32 v108, v108
    v_mfma_f32_32x32x16_bf16 v[120:135], v[40:43], v[32:35], v[88:103]
    v_exp_f32 v109, v109
    v_exp_f32 v110, v110
    v_exp_f32 v111, v111
    v_mfma_f32_32x32x16_bf16 v[120:135], v[44:47], v[36:39], v[120:135]
    s_waitcnt lgkmcnt(1)
    v_exp_f32 v112, v112
    v_exp_f32 v113, v113
    v_exp_f32 v114, v114
    v_smfmac_f32_32x32x32_bf16 v[136:151], v[56:59], v[104:111], v4
    v_add_u32 v3, 32768, v2
    v_exp_f32 v115, v115
    v_exp_f32 v116, v116
    v_exp_f32 v117, v117
    v_exp_f32 v118, v118
    v_exp_f32 v119, v119
    v_smfmac_f32_16x16x64_bf16 v[12:15], v[8:11], v[104:111], v4
    ds_read_b128 v[68:71], v2 offset:7168
    v_exp_f32 v120, v120
    v_smfmac_f32_32x32x32_bf16 v[136:151], v[60:63], v[112:119], v4
    v_exp_f32 v121, v121
    v_exp_f32 v122, v122
    v_exp_f32 v123, v123
    v_smfmac_f32_16x16x64_bf16 v[12:15], v[8:11], v[112:119], v4
    ds_read_b128 v[40:43], v20 offset:8192
    v_exp_f32 v124, v124
    v_mfma_f32_32x32x16_bf16 v[104:119], v[48:51], v[24:27], v[72:87]
    v_exp_f32 v125, v125
    v_exp_f32 v126, v126
    v_exp_f32 v127, v127
    v_mfma_f32_32x32x16_bf16 v[104:119], v[52:55], v[28:31], v[104:119]
    s_cbranch_vccnz L_p2_pub
L_p2_pubret:
    v_exp_f32 v128, v128
    v_exp_f32 v129, v129
    v_exp_f32 v130, v130
    v_smfmac_f32_32x32x32_bf16 v[152:167], v[56:59], v[120:127], v4
    v_and_b32 v3, 131071, v3
    v_exp_f32 v131, v131
    v_exp_f32 v132, v132
    v_exp_f32 v133, v133
    v_exp_f32 v134, v134
    v_exp_f32 v135, v135
    v_smfmac_f32_16x16x64_bf16 v[16:19], v[8:11], v[120:127], v4
    ds_read_b128 v[44:47], v20 offset:9216
    v_exp_f32 v104, v104
    v_smfmac_f32_32x32x32_bf16 v[152:167], v[60:63], v[128:135], v4
    v_exp_f32 v105, v105
    v_exp_f32 v106, v106
    v_exp_f32 v107, v107
    v_smfmac_f32_16x16x64_bf16 v[16:19], v[8:11], v[128:135], v4
    ds_read_b128 v[56:59], v2 offset:10240
    v_exp_f32 v108, v108
    v_mfma_f32_32x32x16_bf16 v[120:135], v[48:51], v[32:35], v[88:103]
    v_exp_f32 v109, v109
    v_exp_f32 v110, v110
    v_exp_f32 v111, v111
    v_mfma_f32_32x32x16_bf16 v[120:135], v[52:55], v[36:39], v[120:135]
    s_waitcnt lgkmcnt(1)
    v_exp_f32 v112, v112
    v_exp_f32 v113, v113
    v_exp_f32 v114, v114
    v_smfmac_f32_32x32x32_bf16 v[136:151], v[64:67], v[104:111], v4
    v_xor_b32 v21, v23, v3
    v_exp_f32 v115, v115
    v_exp_f32 v116, v116
    v_exp_f32 v117, v117
    v_exp_f32 v118, v118
    v_exp_f32 v119, v119
    v_smfmac_f32_16x16x64_bf16 v[12:15], v[8:11], v[104:111], v4
    ds_read_b128 v[60:63], v2 offset:11264
    v_exp_f32 v120, v120
    v_smfmac_f32_32x32x32_bf16 v[136:151], v[68:71], v[112:119], v4
    v_exp_f32 v121, v121
    v_exp_f32 v122, v122
    v_exp_f32 v123, v123
    v_smfmac_f32_16x16x64_bf16 v[12:15], v[8:11], v[112:119], v4
    ds_read_b128 v[48:51], v20 offset:12288
    v_exp_f32 v124, v124
    v_mfma_f32_32x32x16_bf16 v[104:119], v[40:43], v[24:27], v[72:87]
    v_exp_f32 v125, v125
    v_exp_f32 v126, v126
    v_exp_f32 v127, v127
    v_mfma_f32_32x32x16_bf16 v[104:119], v[44:47], v[28:31], v[104:119]
    s_nop 0
    v_exp_f32 v128, v128
    v_exp_f32 v129, v129
    v_exp_f32 v130, v130
    v_smfmac_f32_32x32x32_bf16 v[152:167], v[64:67], v[120:127], v4
    v_exp_f32 v131, v131
    v_exp_f32 v132, v132
    v_exp_f32 v133, v133
    v_exp_f32 v134, v134
    v_exp_f32 v135, v135
    v_smfmac_f32_16x16x64_bf16 v[16:19], v[8:11], v[120:127], v4
    ds_read_b128 v[52:55], v20 offset:13312
    v_exp_f32 v104, v104
    v_smfmac_f32_32x32x32_bf16 v[152:167], v[68:71], v[128:135], v4
    v_exp_f32 v105, v105
    v_exp_f32 v106, v106
    v_exp_f32 v107, v107
    v_smfmac_f32_16x16x64_bf16 v[16:19], v[8:11], v[128:135], v4
    ds_read_b128 v[64:67], v2 offset:14336
    v_exp_f32 v108, v108
    v_mfma_f32_32x32x16_bf16 v[120:135], v[40:43], v[32:35], v[88:103]
    v_exp_f32 v109, v109
    v_exp_f32 v110, v110
    v_exp_f32 v111, v111
    v_mfma_f32_32x32x16_bf16 v[120:135], v[44:47], v[36:39], v[120:135]
    s_waitcnt lgkmcnt(1)
    v_exp_f32 v112, v112
    v_exp_f32 v113, v113
    v_exp_f32 v114, v114
    v_smfmac_f32_32x32x32_bf16 v[136:151], v[56:59], v[104:111], v4
    v_exp_f32 v115, v115
    v_exp_f32 v116, v116
    v_exp_f32 v117, v117
    v_exp_f32 v118, v118
    v_exp_f32 v119, v119
    v_smfmac_f32_16x16x64_bf16 v[12:15], v[8:11], v[104:111], v4
    ds_read_b128 v[68:71], v2 offset:15360
    v_exp_f32 v120, v120
    v_smfmac_f32_32x32x32_bf16 v[136:151], v[60:63], v[112:119], v4
    v_exp_f32 v121, v121
    v_exp_f32 v122, v122
    v_exp_f32 v123, v123
    v_smfmac_f32_16x16x64_bf16 v[12:15], v[8:11], v[112:119], v4
    ds_read_b128 v[40:43], v20 offset:16384
    v_exp_f32 v124, v124
    v_mfma_f32_32x32x16_bf16 v[104:119], v[48:51], v[24:27], v[72:87]
    v_exp_f32 v125, v125
    v_exp_f32 v126, v126
    v_exp_f32 v127, v127
    v_mfma_f32_32x32x16_bf16 v[104:119], v[52:55], v[28:31], v[104:119]
    s_nop 0
    v_exp_f32 v128, v128
    v_exp_f32 v129, v129
    v_exp_f32 v130, v130
    v_smfmac_f32_32x32x32_bf16 v[152:167], v[56:59], v[120:127], v4
    v_exp_f32 v131, v131
    v_exp_f32 v132, v132
    v_exp_f32 v133, v133
    v_exp_f32 v134, v134
    v_exp_f32 v135, v135
    v_smfmac_f32_16x16x64_bf16 v[16:19], v[8:11], v[120:127], v4
    ds_read_b128 v[44:47], v20 offset:17408
    v_exp_f32 v104, v104
    v_smfmac_f32_32x32x32_bf16 v[152:167], v[60:63], v[128:135], v4
    v_exp_f32 v105, v105
    v_exp_f32 v106, v106
    v_exp_f32 v107, v107
    v_smfmac_f32_16x16x64_bf16 v[16:19], v[8:11], v[128:135], v4
    ds_read_b128 v[56:59], v2 offset:18432
    v_exp_f32 v108, v108
    v_mfma_f32_32x32x16_bf16 v[120:135], v[48:51], v[32:35], v[88:103]
    v_exp_f32 v109, v109
    v_exp_f32 v110, v110
    v_exp_f32 v111, v111
    v_mfma_f32_32x32x16_bf16 v[120:135], v[52:55], v[36:39], v[120:135]
    s_waitcnt lgkmcnt(1)
    v_exp_f32 v112, v112
    v_exp_f32 v113, v113
    v_exp_f32 v114, v114
    v_smfmac_f32_32x32x32_bf16 v[136:151], v[64:67], v[104:111], v4
    v_exp_f32 v115, v115
    v_exp_f32 v116, v116
    v_exp_f32 v117, v117
    v_exp_f32 v118, v118
    v_exp_f32 v119, v119
    v_smfmac_f32_16x16x64_bf16 v[12:15], v[8:11], v[104:111], v4
    ds_read_b128 v[60:63], v2 offset:19456
    v_exp_f32 v120, v120
    v_smfmac_f32_32x32x32_bf16 v[136:151], v[68:71], v[112:119], v4
    v_exp_f32 v121, v121
    v_exp_f32 v122, v122
    v_exp_f32 v123, v123
    v_smfmac_f32_16x16x64_bf16 v[12:15], v[8:11], v[112:119], v4
    ds_read_b128 v[48:51], v20 offset:20480
    v_exp_f32 v124, v124
    v_mfma_f32_32x32x16_bf16 v[104:119], v[40:43], v[24:27], v[72:87]
    v_exp_f32 v125, v125
    v_exp_f32 v126, v126
    v_exp_f32 v127, v127
    v_mfma_f32_32x32x16_bf16 v[104:119], v[44:47], v[28:31], v[104:119]
    s_nop 0
    v_exp_f32 v128, v128
    v_exp_f32 v129, v129
    v_exp_f32 v130, v130
    v_smfmac_f32_32x32x32_bf16 v[152:167], v[64:67], v[120:127], v4
    v_exp_f32 v131, v131
    v_exp_f32 v132, v132
    v_exp_f32 v133, v133
    v_exp_f32 v134, v134
    v_exp_f32 v135, v135
    v_smfmac_f32_16x16x64_bf16 v[16:19], v[8:11], v[120:127], v4
    ds_read_b128 v[52:55], v20 offset:21504
    v_exp_f32 v104, v104
    v_smfmac_f32_32x32x32_bf16 v[152:167], v[68:71], v[128:135], v4
    v_exp_f32 v105, v105
    v_exp_f32 v106, v106
    v_exp_f32 v107, v107
    v_smfmac_f32_16x16x64_bf16 v[16:19], v[8:11], v[128:135], v4
    ds_read_b128 v[64:67], v2 offset:22528
    v_exp_f32 v108, v108
    v_mfma_f32_32x32x16_bf16 v[120:135], v[40:43], v[32:35], v[88:103]
    v_exp_f32 v109, v109
    v_exp_f32 v110, v110
    v_exp_f32 v111, v111
    v_mfma_f32_32x32x16_bf16 v[120:135], v[44:47], v[36:39], v[120:135]
    s_waitcnt lgkmcnt(1)
    v_exp_f32 v112, v112
    v_exp_f32 v113, v113
    v_exp_f32 v114, v114
    v_smfmac_f32_32x32x32_bf16 v[136:151], v[56:59], v[104:111], v4
    v_exp_f32 v115, v115
    v_exp_f32 v116, v116
    v_exp_f32 v117, v117
    v_exp_f32 v118, v118
    v_exp_f32 v119, v119
    v_smfmac_f32_16x16x64_bf16 v[12:15], v[8:11], v[104:111], v4
    ds_read_b128 v[68:71], v2 offset:23552
    v_exp_f32 v120, v120
    v_smfmac_f32_32x32x32_bf16 v[136:151], v[60:63], v[112:119], v4
    v_exp_f32 v121, v121
    v_exp_f32 v122, v122
    v_exp_f32 v123, v123
    v_smfmac_f32_16x16x64_bf16 v[12:15], v[8:11], v[112:119], v4
    ds_read_b128 v[40:43], v20 offset:24576
    v_exp_f32 v124, v124
    v_mfma_f32_32x32x16_bf16 v[104:119], v[48:51], v[24:27], v[72:87]
    v_exp_f32 v125, v125
    v_exp_f32 v126, v126
    v_exp_f32 v127, v127
    v_mfma_f32_32x32x16_bf16 v[104:119], v[52:55], v[28:31], v[104:119]
    s_nop 0
    v_exp_f32 v128, v128
    v_exp_f32 v129, v129
    v_exp_f32 v130, v130
    v_smfmac_f32_32x32x32_bf16 v[152:167], v[56:59], v[120:127], v4
    v_exp_f32 v131, v131
    v_exp_f32 v132, v132
    v_exp_f32 v133, v133
    v_exp_f32 v134, v134
    v_exp_f32 v135, v135
    v_smfmac_f32_16x16x64_bf16 v[16:19], v[8:11], v[120:127], v4
    ds_read_b128 v[44:47], v20 offset:25600
    v_exp_f32 v104, v104
    v_smfmac_f32_32x32x32_bf16 v[152:167], v[60:63], v[128:135], v4
    v_exp_f32 v105, v105
    v_exp_f32 v106, v106
    v_exp_f32 v107, v107
    v_smfmac_f32_16x16x64_bf16 v[16:19], v[8:11], v[128:135], v4
    ds_read_b128 v[56:59], v2 offset:26624
    v_exp_f32 v108, v108
    v_mfma_f32_32x32x16_bf16 v[120:135], v[48:51], v[32:35], v[88:103]
    v_exp_f32 v109, v109
    v_exp_f32 v110, v110
    v_exp_f32 v111, v111
    v_mfma_f32_32x32x16_bf16 v[120:135], v[52:55], v[36:39], v[120:135]
    s_waitcnt lgkmcnt(1)
    v_exp_f32 v112, v112
    v_exp_f32 v113, v113
    v_exp_f32 v114, v114
    v_smfmac_f32_32x32x32_bf16 v[136:151], v[64:67], v[104:111], v4
    v_exp_f32 v115, v115
    v_exp_f32 v116, v116
    v_exp_f32 v117, v117
    v_exp_f32 v118, v118
    v_exp_f32 v119, v119
    v_smfmac_f32_16x16x64_bf16 v[12:15], v[8:11], v[104:111], v4
    ds_read_b128 v[60:63], v2 offset:27648
    v_exp_f32 v120, v120
    v_smfmac_f32_32x32x32_bf16 v[136:151], v[68:71], v[112:119], v4
    v_exp_f32 v121, v121
    v_exp_f32 v122, v122
    v_exp_f32 v123, v123
    v_smfmac_f32_16x16x64_bf16 v[12:15], v[8:11], v[112:119], v4
    ds_read_b128 v[48:51], v20 offset:28672
    v_exp_f32 v124, v124
    v_mfma_f32_32x32x16_bf16 v[104:119], v[40:43], v[24:27], v[72:87]
    v_exp_f32 v125, v125
    v_exp_f32 v126, v126
    v_exp_f32 v127, v127
    v_mfma_f32_32x32x16_bf16 v[104:119], v[44:47], v[28:31], v[104:119]
    s_nop 0
    v_exp_f32 v128, v128
    v_exp_f32 v129, v129
    v_exp_f32 v130, v130
    v_smfmac_f32_32x32x32_bf16 v[152:167], v[64:67], v[120:127], v4
    v_exp_f32 v131, v131
    v_exp_f32 v132, v132
    v_exp_f32 v133, v133
    v_exp_f32 v134, v134
    v_exp_f32 v135, v135
    v_smfmac_f32_16x16x64_bf16 v[16:19], v[8:11], v[120:127], v4
    ds_read_b128 v[52:55], v20 offset:29696
    v_exp_f32 v104, v104
    v_smfmac_f32_32x32x32_bf16 v[152:167], v[68:71], v[128:135], v4
    v_exp_f32 v105, v105
    v_exp_f32 v106, v106
    v_exp_f32 v107, v107
    v_smfmac_f32_16x16x64_bf16 v[16:19], v[8:11], v[128:135], v4
    ds_read_b128 v[64:67], v2 offset:30720
    v_exp_f32 v108, v108
    v_mfma_f32_32x32x16_bf16 v[120:135], v[40:43], v[32:35], v[88:103]
    v_exp_f32 v109, v109
    v_exp_f32 v110, v110
    v_exp_f32 v111, v111
    v_mfma_f32_32x32x16_bf16 v[120:135], v[44:47], v[36:39], v[120:135]
    s_waitcnt lgkmcnt(1)
    v_exp_f32 v112, v112
    v_exp_f32 v113, v113
    v_exp_f32 v114, v114
    v_smfmac_f32_32x32x32_bf16 v[136:151], v[56:59], v[104:111], v4
    v_exp_f32 v115, v115
    v_exp_f32 v116, v116
    v_exp_f32 v117, v117
    v_exp_f32 v118, v118
    v_exp_f32 v119, v119
    v_smfmac_f32_16x16x64_bf16 v[12:15], v[8:11], v[104:111], v4
    ds_read_b128 v[68:71], v2 offset:31744
    v_exp_f32 v120, v120
    v_smfmac_f32_32x32x32_bf16 v[136:151], v[60:63], v[112:119], v4
    s_barrier
    v_exp_f32 v121, v121
    v_exp_f32 v122, v122
    v_exp_f32 v123, v123
    v_smfmac_f32_16x16x64_bf16 v[12:15], v[8:11], v[112:119], v4
    ds_read_b128 v[40:43], v21 offset:0
    v_exp_f32 v124, v124
    v_mfma_f32_32x32x16_bf16 v[104:119], v[48:51], v[24:27], v[72:87]
    v_exp_f32 v125, v125
    v_exp_f32 v126, v126
    v_exp_f32 v127, v127
    v_mfma_f32_32x32x16_bf16 v[104:119], v[52:55], v[28:31], v[104:119]
    s_nop 0
    v_exp_f32 v128, v128
    v_exp_f32 v129, v129
    v_exp_f32 v130, v130
    v_smfmac_f32_32x32x32_bf16 v[152:167], v[56:59], v[120:127], v4
    v_mov_b32 v20, v21
    v_exp_f32 v131, v131
    v_exp_f32 v132, v132
    v_exp_f32 v133, v133
    v_exp_f32 v134, v134
    v_exp_f32 v135, v135
    v_smfmac_f32_16x16x64_bf16 v[16:19], v[8:11], v[120:127], v4
    ds_read_b128 v[44:47], v21 offset:1024
    v_exp_f32 v104, v104
    v_smfmac_f32_32x32x32_bf16 v[152:167], v[60:63], v[128:135], v4
    v_exp_f32 v105, v105
    v_exp_f32 v106, v106
    v_exp_f32 v107, v107
    v_smfmac_f32_16x16x64_bf16 v[16:19], v[8:11], v[128:135], v4
    ds_read_b128 v[56:59], v3 offset:2048
    v_exp_f32 v108, v108
    v_mfma_f32_32x32x16_bf16 v[120:135], v[48:51], v[32:35], v[88:103]
    v_exp_f32 v109, v109
    v_exp_f32 v110, v110
    v_exp_f32 v111, v111
    v_mfma_f32_32x32x16_bf16 v[120:135], v[52:55], v[36:39], v[120:135]
    s_waitcnt lgkmcnt(1)
    v_exp_f32 v112, v112
    v_exp_f32 v113, v113
    v_exp_f32 v114, v114
    v_smfmac_f32_32x32x32_bf16 v[136:151], v[64:67], v[104:111], v4
    s_add_u32 s28, s28, 1
    v_exp_f32 v115, v115
    v_exp_f32 v116, v116
    v_exp_f32 v117, v117
    v_exp_f32 v118, v118
    v_exp_f32 v119, v119
    v_smfmac_f32_16x16x64_bf16 v[12:15], v[8:11], v[104:111], v4
    ds_read_b128 v[60:63], v3 offset:3072
    v_exp_f32 v120, v120
    v_smfmac_f32_32x32x32_bf16 v[136:151], v[68:71], v[112:119], v4
    v_exp_f32 v121, v121
    v_exp_f32 v122, v122
    v_exp_f32 v123, v123
    v_smfmac_f32_16x16x64_bf16 v[12:15], v[8:11], v[112:119], v4
    ds_read_b128 v[48:51], v21 offset:4096
    v_exp_f32 v124, v124
    v_mfma_f32_32x32x16_bf16 v[104:119], v[40:43], v[24:27], v[72:87]
    v_mov_b32 v2, v3
    v_exp_f32 v125, v125
    v_exp_f32 v126, v126
    v_exp_f32 v127, v127
    v_mfma_f32_32x32x16_bf16 v[104:119], v[44:47], v[28:31], v[104:119]
    s_nop 0
    v_exp_f32 v128, v128
    v_exp_f32 v129, v129
    v_exp_f32 v130, v130
    v_smfmac_f32_32x32x32_bf16 v[152:167], v[64:67], v[120:127], v4
    s_cmp_lt_u32 s28, 8
    v_exp_f32 v131, v131
    v_exp_f32 v132, v132
    v_exp_f32 v133, v133
    v_exp_f32 v134, v134
    v_exp_f32 v135, v135
    v_smfmac_f32_16x16x64_bf16 v[16:19], v[8:11], v[120:127], v4
    ds_read_b128 v[52:55], v21 offset:5120
    s_cbranch_scc1 L_p2_loop
    s_nop 1
    v_smfmac_f32_32x32x32_bf16 v[152:167], v[68:71], v[128:135], v4
    v_smfmac_f32_16x16x64_bf16 v[16:19], v[8:11], v[128:135], v4
    s_mov_b32 s48, 0
    s_mov_b32 s36, 0x71800000
    v_pk_mul_f32 v[6:7], v[136:137], 0
    v_pk_fma_f32 v[6:7], v[138:139], 0, v[6:7]
    v_pk_fma_f32 v[6:7], v[140:141], 0, v[6:7]
    v_pk_fma_f32 v[6:7], v[142:143], 0, v[6:7]
    v_pk_fma_f32 v[6:7], v[144:145], 0, v[6:7]
    v_pk_fma_f32 v[6:7], v[146:147], 0, v[6:7]
    v_pk_fma_f32 v[6:7], v[148:149], 0, v[6:7]
    v_pk_fma_f32 v[6:7], v[150:151], 0, v[6:7]
    v_add_f32 v6, v6, v7
    v_add_f32 v6, v6, v12
    v_cmp_nlt_f32 vcc, v6, s36
    s_nop 0
    s_cmp_lg_u64 vcc, 0
    s_cbranch_scc1 L_p2_slow0e
L_p2_fin0:
    v_rcp_f32 v12, v12
    s_nop 0
    v_pk_mul_f32 v[136:137], v[136:137], v[12:13] op_sel_hi:[1,0]
    v_pk_mul_f32 v[138:139], v[138:139], v[12:13] op_sel_hi:[1,0]
    v_pk_mul_f32 v[140:141], v[140:141], v[12:13] op_sel_hi:[1,0]
    v_pk_mul_f32 v[142:143], v[142:143], v[12:13] op_sel_hi:[1,0]
    v_pk_mul_f32 v[144:145], v[144:145], v[12:13] op_sel_hi:[1,0]
    v_pk_mul_f32 v[146:147], v[146:147], v[12:13] op_sel_hi:[1,0]
    v_pk_mul_f32 v[148:149], v[148:149], v[12:13] op_sel_hi:[1,0]
    v_pk_mul_f32 v[150:151], v[150:151], v[12:13] op_sel_hi:[1,0]
    v_cvt_pk_bf16_f32 v136, v136, v137
    v_cvt_pk_bf16_f32 v137, v138, v139
    v_cvt_pk_bf16_f32 v138, v140, v141
    v_cvt_pk_bf16_f32 v139, v142, v143
    v_cvt_pk_bf16_f32 v140, v144, v145
    v_cvt_pk_bf16_f32 v141, v146, v147
    v_cvt_pk_bf16_f32 v142, v148, v149
    v_cvt_pk_bf16_f32 v143, v150, v151
    buffer_store_dwordx4 v[136:139], v1, s[16:19], s47 offen sc0 sc1
    buffer_store_dwordx4 v[140:143], v1, s[16:19], s47 offen offset:1024 sc0 sc1
    s_add_u32 s47, s47, 65536
    v_pk_mul_f32 v[6:7], v[152:153], 0
    v_pk_fma_f32 v[6:7], v[154:155], 0, v[6:7]
    v_pk_fma_f32 v[6:7], v[156:157], 0, v[6:7]
    v_pk_fma_f32 v[6:7], v[158:159], 0, v[6:7]
    v_pk_fma_f32 v[6:7], v[160:161], 0, v[6:7]
    v_pk_fma_f32 v[6:7], v[162:163], 0, v[6:7]
    v_pk_fma_f32 v[6:7], v[164:165], 0, v[6:7]
    v_pk_fma_f32 v[6:7], v[166:167], 0, v[6:7]
    v_add_f32 v6, v6, v7
    v_add_f32 v6, v6, v16
    v_cmp_nlt_f32 vcc, v6, s36
    s_nop 0
    s_cmp_lg_u64 vcc, 0
    s_cbranch_scc1 L_p2_slow1e
L_p2_fin1:
    v_rcp_f32 v16, v16
    s_nop 0
    v_pk_mul_f32 v[152:153], v[152:153], v[16:17] op_sel_hi:[1,0]
    v_pk_mul_f32 v[154:155], v[154:155], v[16:17] op_sel_hi:[1,0]
    v_pk_mul_f32 v[156:157], v[156:157], v[16:17] op_sel_hi:[1,0]
    v_pk_mul_f32 v[158:159], v[158:159], v[16:17] op_sel_hi:[1,0]
    v_pk_mul_f32 v[160:161], v[160:161], v[16:17] op_sel_hi:[1,0]
    v_pk_mul_f32 v[162:163], v[162:163], v[16:17] op_sel_hi:[1,0]
    v_pk_mul_f32 v[164:165], v[164:165], v[16:17] op_sel_hi:[1,0]
    v_pk_mul_f32 v[166:167], v[166:167], v[16:17] op_sel_hi:[1,0]
    v_cvt_pk_bf16_f32 v152, v152, v153
    v_cvt_pk_bf16_f32 v153, v154, v155
    v_cvt_pk_bf16_f32 v154, v156, v157
    v_cvt_pk_bf16_f32 v155, v158, v159
    v_cvt_pk_bf16_f32 v156, v160, v161
    v_cvt_pk_bf16_f32 v157, v162, v163
    v_cvt_pk_bf16_f32 v158, v164, v165
    v_cvt_pk_bf16_f32 v159, v166, v167
    buffer_store_dwordx4 v[152:155], v1, s[16:19], s47 offen sc0 sc1
    buffer_store_dwordx4 v[156:159], v1, s[16:19], s47 offen offset:1024 sc0 sc1
    s_branch L_p2_out
L_p2_slow1e:
    s_mov_b32 s48, 1
    v_mov_b32 v24, v32
    v_mov_b32 v25, v33
    v_mov_b32 v26, v34
    v_mov_b32 v27, v35
    v_mov_b32 v28, v36
    v_mov_b32 v29, v37
    v_mov_b32 v30, v38
    v_mov_b32 v31, v39
L_p2_slow0e:
    s_branch L_p2_slow
L_p2_slowret:
    s_mov_b32 s36, 0x71800000
    s_cmp_eq_u32 s48, 0
    s_cbranch_scc1 L_p2_fin0
    v_mov_b32 v152, v136
    v_mov_b32 v153, v137
    v_mov_b32 v154, v138
    v_mov_b32 v155, v139
    v_mov_b32 v156, v140
    v_mov_b32 v157, v141
    v_mov_b32 v158, v142
    v_mov_b32 v159, v143
    v_mov_b32 v160, v144
    v_mov_b32 v161, v145
    v_mov_b32 v162, v146
    v_mov_b32 v163, v147
    v_mov_b32 v164, v148
    v_mov_b32 v165, v149
    v_mov_b32 v166, v150
    v_mov_b32 v167, v151
    v_mov_b32 v16, v12
    s_branch L_p2_fin1
L_p2_pub:
    s_waitcnt vmcnt(0)
    v_mov_b32 v6, 1
    v_lshlrev_b32 v7, 2, v0
    s_mov_b64 exec, vcc
    buffer_atomic_add v6, v7, s[16:19], s49 offen sc1
    s_mov_b64 exec, -1
    s_mov_b64 vcc, 0
    s_barrier
    s_nop 4
    s_branch L_p2_pubret
L_p2_slow:
    s_waitcnt lgkmcnt(0)
    s_mov_b32 s36, s40
    s_mov_b32 s28, 0
    v_mov_b32 v6, 0xff800000
L_p2_slow1:
    buffer_load_dwordx4 v[40:43], v22, s[16:19], s36 offen sc1
    buffer_load_dwordx4 v[44:47], v22, s[16:19], s36 offen offset:1024 sc1
    s_waitcnt vmcnt(0)
    v_mfma_f32_32x32x16_bf16 v[104:119], v[40:43], v[24:27], 0
    v_mfma_f32_32x32x16_bf16 v[104:119], v[44:47], v[28:31], v[104:119]
    s_nop 11
    v_max3_f32 v6, v6, v104, v105
    v_max3_f32 v6, v6, v106, v107
    v_max3_f32 v6, v6, v108, v109
    v_max3_f32 v6, v6, v110, v111
    v_max3_f32 v6, v6, v112, v113
    v_max3_f32 v6, v6, v114, v115
    v_max3_f32 v6, v6, v116, v117
    v_max3_f32 v6, v6, v118, v119
    s_add_u32 s28, s28, 1
    s_and_b32 s29, s28, 7
    s_cselect_b32 s29, 0, 768
    s_add_u32 s36, s36, s29
    s_add_u32 s36, s36, 4096
    s_cmp_lt_u32 s28, 64
    s_cbranch_scc1 L_p2_slow1
    v_mov_b32 v7, v6
    s_nop 1
    v_permlane32_swap_b32 v6, v7
    v_max_f32 v6, v6, v7
    v_sub_f32 v6, 0, v6
    v_pk_mov_b32 v[72:73], v[6:7], v[6:7] op_sel:[0,0]
    v_pk_mov_b32 v[74:75], v[6:7], v[6:7] op_sel:[0,0]
    v_pk_mov_b32 v[76:77], v[6:7], v[6:7] op_sel:[0,0]
    v_pk_mov_b32 v[78:79], v[6:7], v[6:7] op_sel:[0,0]
    v_pk_mov_b32 v[80:81], v[6:7], v[6:7] op_sel:[0,0]
    v_pk_mov_b32 v[82:83], v[6:7], v[6:7] op_sel:[0,0]
    v_pk_mov_b32 v[84:85], v[6:7], v[6:7] op_sel:[0,0]
    v_pk_mov_b32 v[86:87], v[6:7], v[6:7] op_sel:[0,0]
    v_mov_b32 v136, 0
    v_mov_b32 v137, 0
    v_mov_b32 v138, 0
    v_mov_b32 v139, 0
    v_mov_b32 v140, 0
    v_mov_b32 v141, 0
    v_mov_b32 v142, 0
    v_mov_b32 v143, 0
    v_mov_b32 v144, 0
    v_mov_b32 v145, 0
    v_mov_b32 v146, 0
    v_mov_b32 v147, 0
    v_mov_b32 v148, 0
    v_mov_b32 v149, 0
    v_mov_b32 v150, 0
    v_mov_b32 v151, 0
    v_mov_b32 v12, 0
    v_mov_b32 v13, 0
    v_mov_b32 v14, 0
    v_mov_b32 v15, 0
    s_mov_b32 s36, s40
    s_mov_b32 s28, 0
L_p2_slow2:
    buffer_load_dwordx4 v[40:43], v22, s[16:19], s36 offen sc1
    buffer_load_dwordx4 v[44:47], v22, s[16:19], s36 offen offset:1024 sc1
    buffer_load_dwordx4 v[56:59], v1, s[16:19], s36 offen offset:2048 sc1
    buffer_load_dwordx4 v[60:63], v1, s[16:19], s36 offen offset:3072 sc1
    s_waitcnt vmcnt(0)
    v_mfma_f32_32x32x16_bf16 v[104:119], v[40:43], v[24:27], v[72:87]
    v_mfma_f32_32x32x16_bf16 v[104:119], v[44:47], v[28:31], v[104:119]
    s_nop 11
    v_exp_f32 v104, v104
    v_exp_f32 v105, v105
    v_exp_f32 v106, v106
    v_exp_f32 v107, v107
    v_exp_f32 v108, v108
    v_exp_f32 v109, v109
    v_exp_f32 v110, v110
    v_exp_f32 v111, v111
    v_exp_f32 v112, v112
    v_exp_f32 v113, v113
    v_exp_f32 v114, v114
    v_exp_f32 v115, v115
    v_exp_f32 v116, v116
    v_exp_f32 v117, v117
    v_exp_f32 v118, v118
    v_exp_f32 v119, v119
    v_smfmac_f32_32x32x32_bf16 v[136:151], v[56:59], v[104:111], v4
    v_smfmac_f32_16x16x64_bf16 v[12:15], v[8:11], v[104:111], v4
    v_smfmac_f32_32x32x32_bf16 v[136:151], v[60:63], v[112:119], v4
    v_smfmac_f32_16x16x64_bf16 v[12:15], v[8:11], v[112:119], v4
    s_nop 15
    s_add_u32 s28, s28, 1
    s_and_b32 s29, s28, 7
    s_cselect_b32 s29, 0, 768
    s_add_u32 s36, s36, s29
    s_add_u32 s36, s36, 4096
    s_cmp_lt_u32 s28, 64
    s_cbranch_scc1 L_p2_slow2
    s_nop 15
    s_branch L_p2_slowret
L_p2_out:
    s_lshl_b32 s49, s25, 1
    s_lshr_b32 s29, s27, 1
    s_add_u32 s49, s49, s29
    s_mul_i32 s49, s49, 128
    s_mul_i32 s29, s34, 4
    s_add_u32 s49, s49, s29
    s_add_u32 s49, s49, 30457856
    s_waitcnt lgkmcnt(0)
    s_mov_b32 s24, s99
    s_and_b32 s25, s3, 3
    s_lshl_b32 s25, s25, 2
    s_bfe_u32 s29, s2, 0x20004
    s_add_u32 s25, s25, s29
    s_and_b32 s26, s3, 4
    s_lshr_b32 s29, s2, 6
    s_add_u32 s26, s26, s29
    s_lshr_b32 s36, s27, 1
    s_and_b32 s37, s27, 1
    v_and_b32 v7, 15, v0
    v_lshrrev_b32 v6, 4, v0
    v_lshlrev_b32 v1, 4, v7
    v_lshl_add_u32 v1, v6, 9, v1
    s_lshl_b32 s29, s36, 13
    v_add_u32 v1, s29, v1
    v_bfe_u32 v3, v0, 2, 3
    v_lshrrev_b32 v2, 5, v0
    v_lshl_add_u32 v2, v2, 4, v3
    v_lshlrev_b32 v2, 8, v2
    s_lshl_b32 s29, s37, 2
    v_xor_b32 v3, s29, v3
    v_lshl_add_u32 v2, v3, 5, v2
    v_and_b32 v3, 3, v0
    v_lshl_add_u32 v2, v3, 3, v2
    v_add_u32 v2, 16384, v2
    s_mov_b32 s30, 0
    v_mov_b32 v3, v1
    v_mov_b32 v4, v2
    v_xor_b32 v5, 32, v2
    v_xor_b32 v6, 64, v2
    v_xor_b32 v7, 0x60, v2
    s_mov_b32 s28, 16
    v_pk_mov_b32 v[72:73], 0, 0
    v_pk_mov_b32 v[74:75], 0, 0
    v_pk_mov_b32 v[76:77], 0, 0
    v_pk_mov_b32 v[78:79], 0, 0
    v_pk_mov_b32 v[80:81], 0, 0
    v_pk_mov_b32 v[82:83], 0, 0
    v_pk_mov_b32 v[84:85], 0, 0
    v_pk_mov_b32 v[86:87], 0, 0
    v_pk_mov_b32 v[88:89], 0, 0
    v_pk_mov_b32 v[90:91], 0, 0
    v_pk_mov_b32 v[92:93], 0, 0
    v_pk_mov_b32 v[94:95], 0, 0
    v_pk_mov_b32 v[96:97], 0, 0
    v_pk_mov_b32 v[98:99], 0, 0
    v_pk_mov_b32 v[100:101], 0, 0
    v_pk_mov_b32 v[102:103], 0, 0
    v_pk_mov_b32 v[104:105], 0, 0
    v_pk_mov_b32 v[106:107], 0, 0
    v_pk_mov_b32 v[108:109], 0, 0
    v_pk_mov_b32 v[110:111], 0, 0
    v_pk_mov_b32 v[112:113], 0, 0
    v_pk_mov_b32 v[114:115], 0, 0
    v_pk_mov_b32 v[116:117], 0, 0
    v_pk_mov_b32 v[118:119], 0, 0
    v_pk_mov_b32 v[120:121], 0, 0
    v_pk_mov_b32 v[122:123], 0, 0
    v_pk_mov_b32 v[124:125], 0, 0
    v_pk_mov_b32 v[126:127], 0, 0
    v_pk_mov_b32 v[128:129], 0, 0
    v_pk_mov_b32 v[130:131], 0, 0
    v_pk_mov_b32 v[132:133], 0, 0
    v_pk_mov_b32 v[134:135], 0, 0
    s_lshl_b32 s38, s25, 7
    s_lshl_b32 s29, s36, 6
    s_add_u32 s38, s38, s29
    s_lshl_b32 s38, s38, 12
    s_lshl_b32 s29, s24, 11
    s_add_u32 s38, s38, s29
    s_lshl_b32 s29, s26, 8
    s_add_u32 s38, s38, s29
    s_lshl_b32 s29, s37, 7
    s_add_u32 s38, s38, s29
    s_mul_i32 s29, s27, 9216
    s_add_u32 s29, s29, 65536
    v_and_b32 v170, 15, v0
    v_mul_u32_u24 v170, 144, v170
    v_lshrrev_b32 v171, 4, v0
    v_lshl_add_u32 v170, v171, 3, v170
    v_add_u32 v170, s29, v170
    v_lshrrev_b32 v171, 3, v0
    v_and_b32 v172, 7, v0
    v_mul_u32_u24 v173, 144, v171
    v_lshl_add_u32 v173, v172, 4, v173
    v_add_u32 v173, s29, v173
    v_lshlrev_b32 v171, 12, v171
    v_lshl_add_u32 v171, v172, 4, v171
    v_mov_b32 v174, 1
    v_mul_u32_u24 v175, 2048, v0
    s_waitcnt vmcnt(0)
    s_mov_b64 exec, 15
    buffer_atomic_add v174, v175, s[16:19], s49 offen sc1
    s_mov_b64 exec, -1
    s_barrier
    s_barrier
    ds_read_b64_tr_b16 v[40:41], v4 offset:0
    ds_read_b64_tr_b16 v[42:43], v4 offset:2048
    ds_read_b128 v[8:11], v3 offset:0
    ds_read_b128 v[12:15], v3 offset:256
    ds_read_b128 v[16:19], v3 offset:4096
    ds_read_b128 v[20:23], v3 offset:4352
    ds_read_b64_tr_b16 v[44:45], v5 offset:0
    ds_read_b64_tr_b16 v[46:47], v5 offset:2048
    ds_read_b64_tr_b16 v[48:49], v6 offset:0
    ds_read_b64_tr_b16 v[50:51], v6 offset:2048
    ds_read_b64_tr_b16 v[52:53], v7 offset:0
    ds_read_b64_tr_b16 v[54:55], v7 offset:2048
.p2align 6
L_p3_loop:
    s_waitcnt lgkmcnt(6)
    v_mfma_f32_16x16x32_bf16 v[72:75], v[40:43], v[8:11], v[72:75]
    s_add_u32 s30, s30, 32768
    s_cmp_eq_u32 s30, 163840
    v_mfma_f32_16x16x32_bf16 v[88:91], v[40:43], v[12:15], v[88:91]
    ds_read_b64_tr_b16 v[56:57], v4 offset:8192
    s_cselect_b32 s30, 0, s30
    v_mfma_f32_16x16x32_bf16 v[104:107], v[40:43], v[16:19], v[104:107]
    ds_read_b64_tr_b16 v[58:59], v4 offset:10240
    v_mfma_f32_16x16x32_bf16 v[120:123], v[40:43], v[20:23], v[120:123]
    ds_read_b128 v[24:27], v3 offset:2048
    s_waitcnt lgkmcnt(7)
    v_mfma_f32_16x16x32_bf16 v[76:79], v[44:47], v[8:11], v[76:79]
    ds_read_b128 v[28:31], v3 offset:2304
    v_mfma_f32_16x16x32_bf16 v[92:95], v[44:47], v[12:15], v[92:95]
    ds_read_b128 v[32:35], v3 offset:6144
    v_mfma_f32_16x16x32_bf16 v[108:111], v[44:47], v[16:19], v[108:111]
    ds_read_b128 v[36:39], v3 offset:6400
    v_mfma_f32_16x16x32_bf16 v[124:127], v[44:47], v[20:23], v[124:127]
    ds_read_b64_tr_b16 v[60:61], v5 offset:8192
    s_waitcnt lgkmcnt(9)
    v_mfma_f32_16x16x32_bf16 v[80:83], v[48:51], v[8:11], v[80:83]
    ds_read_b64_tr_b16 v[62:63], v5 offset:10240
    v_mfma_f32_16x16x32_bf16 v[96:99], v[48:51], v[12:15], v[96:99]
    ds_read_b64_tr_b16 v[64:65], v6 offset:8192
    v_mfma_f32_16x16x32_bf16 v[112:115], v[48:51], v[16:19], v[112:115]
    ds_read_b64_tr_b16 v[66:67], v6 offset:10240
    v_mfma_f32_16x16x32_bf16 v[128:131], v[48:51], v[20:23], v[128:131]
    ds_read_b64_tr_b16 v[68:69], v7 offset:8192
    s_waitcnt lgkmcnt(11)
    v_mfma_f32_16x16x32_bf16 v[84:87], v[52:55], v[8:11], v[84:87]
    ds_read_b64_tr_b16 v[70:71], v7 offset:10240
    s_cmp_eq_u32 s28, 1
    v_mfma_f32_16x16x32_bf16 v[100:103], v[52:55], v[12:15], v[100:103]
    v_add_u32 v3, s30, v1
    v_add_u32 v4, s30, v2
    v_mfma_f32_16x16x32_bf16 v[116:119], v[52:55], v[16:19], v[116:119]
    v_xor_b32 v5, 32, v4
    v_xor_b32 v6, 64, v4
    v_mfma_f32_16x16x32_bf16 v[132:135], v[52:55], v[20:23], v[132:135]
    v_xor_b32 v7, 0x60, v4
    s_cbranch_scc1 L_p3_last
    s_waitcnt lgkmcnt(6)
    v_mfma_f32_16x16x32_bf16 v[72:75], v[56:59], v[24:27], v[72:75]
    s_barrier
    v_mfma_f32_16x16x32_bf16 v[88:91], v[56:59], v[28:31], v[88:91]
    ds_read_b64_tr_b16 v[40:41], v4 offset:0
    v_mfma_f32_16x16x32_bf16 v[104:107], v[56:59], v[32:35], v[104:107]
    ds_read_b64_tr_b16 v[42:43], v4 offset:2048
    v_mfma_f32_16x16x32_bf16 v[120:123], v[56:59], v[36:39], v[120:123]
    ds_read_b128 v[8:11], v3 offset:0
    s_waitcnt lgkmcnt(7)
    v_mfma_f32_16x16x32_bf16 v[76:79], v[60:63], v[24:27], v[76:79]
    ds_read_b128 v[12:15], v3 offset:256
    v_mfma_f32_16x16x32_bf16 v[92:95], v[60:63], v[28:31], v[92:95]
    ds_read_b128 v[16:19], v3 offset:4096
    v_mfma_f32_16x16x32_bf16 v[108:111], v[60:63], v[32:35], v[108:111]
    ds_read_b128 v[20:23], v3 offset:4352
    v_mfma_f32_16x16x32_bf16 v[124:127], v[60:63], v[36:39], v[124:127]
    ds_read_b64_tr_b16 v[44:45], v5 offset:0
    s_waitcnt lgkmcnt(9)
    v_mfma_f32_16x16x32_bf16 v[80:83], v[64:67], v[24:27], v[80:83]
    ds_read_b64_tr_b16 v[46:47], v5 offset:2048
    v_mfma_f32_16x16x32_bf16 v[96:99], v[64:67], v[28:31], v[96:99]
    ds_read_b64_tr_b16 v[48:49], v6 offset:0
    v_mfma_f32_16x16x32_bf16 v[112:115], v[64:67], v[32:35], v[112:115]
    ds_read_b64_tr_b16 v[50:51], v6 offset:2048
    v_mfma_f32_16x16x32_bf16 v[128:131], v[64:67], v[36:39], v[128:131]
    ds_read_b64_tr_b16 v[52:53], v7 offset:0
    s_waitcnt lgkmcnt(11)
    v_mfma_f32_16x16x32_bf16 v[84:87], v[68:71], v[24:27], v[84:87]
    ds_read_b64_tr_b16 v[54:55], v7 offset:2048
    v_mfma_f32_16x16x32_bf16 v[100:103], v[68:71], v[28:31], v[100:103]
    v_mfma_f32_16x16x32_bf16 v[116:119], v[68:71], v[32:35], v[116:119]
    s_sub_u32 s28, s28, 1
    s_cmp_lg_u32 s28, 0
    v_mfma_f32_16x16x32_bf16 v[132:135], v[68:71], v[36:39], v[132:135]
    s_branch L_p3_loop
L_p3_last:
    s_waitcnt lgkmcnt(4)
    v_mfma_f32_16x16x32_bf16 v[72:75], v[56:59], v[24:27], v[72:75]
    v_mfma_f32_16x16x32_bf16 v[76:79], v[60:63], v[24:27], v[76:79]
    v_mfma_f32_16x16x32_bf16 v[88:91], v[56:59], v[28:31], v[88:91]
    v_mfma_f32_16x16x32_bf16 v[92:95], v[60:63], v[28:31], v[92:95]
    s_waitcnt lgkmcnt(0)
    v_mfma_f32_16x16x32_bf16 v[80:83], v[64:67], v[24:27], v[80:83]
    v_mfma_f32_16x16x32_bf16 v[84:87], v[68:71], v[24:27], v[84:87]
    v_mfma_f32_16x16x32_bf16 v[96:99], v[64:67], v[28:31], v[96:99]
    v_mfma_f32_16x16x32_bf16 v[100:103], v[68:71], v[28:31], v[100:103]
    v_mfma_f32_16x16x32_bf16 v[104:107], v[56:59], v[32:35], v[104:107]
    v_mfma_f32_16x16x32_bf16 v[108:111], v[60:63], v[32:35], v[108:111]
    v_cvt_pk_bf16_f32 v72, v72, v73
    v_cvt_pk_bf16_f32 v73, v74, v75
    v_mfma_f32_16x16x32_bf16 v[112:115], v[64:67], v[32:35], v[112:115]
    v_cvt_pk_bf16_f32 v74, v76, v77
    v_cvt_pk_bf16_f32 v75, v78, v79
    v_mfma_f32_16x16x32_bf16 v[116:119], v[68:71], v[32:35], v[116:119]
    v_cvt_pk_bf16_f32 v76, v80, v81
    v_cvt_pk_bf16_f32 v77, v82, v83
    v_mfma_f32_16x16x32_bf16 v[120:123], v[56:59], v[36:39], v[120:123]
    v_cvt_pk_bf16_f32 v78, v84, v85
    v_cvt_pk_bf16_f32 v79, v86, v87
    v_mfma_f32_16x16x32_bf16 v[124:127], v[60:63], v[36:39], v[124:127]
    ds_write_b64 v170, v[72:73] offset:0
    ds_write_b64 v170, v[74:75] offset:32
    v_mfma_f32_16x16x32_bf16 v[128:131], v[64:67], v[36:39], v[128:131]
    ds_write_b64 v170, v[76:77] offset:64
    ds_write_b64 v170, v[78:79] offset:96
    v_mfma_f32_16x16x32_bf16 v[132:135], v[68:71], v[36:39], v[132:135]
    ds_read_b128 v[176:179], v173 offset:0
    ds_read_b128 v[180:183], v173 offset:1152
    v_cvt_pk_bf16_f32 v88, v88, v89
    v_cvt_pk_bf16_f32 v89, v90, v91
    v_cvt_pk_bf16_f32 v90, v92, v93
    v_cvt_pk_bf16_f32 v91, v94, v95
    v_cvt_pk_bf16_f32 v92, v96, v97
    v_cvt_pk_bf16_f32 v93, v98, v99
    v_cvt_pk_bf16_f32 v94, v100, v101
    v_cvt_pk_bf16_f32 v95, v102, v103
    ds_write_b64 v170, v[88:89] offset:2304
    ds_write_b64 v170, v[90:91] offset:2336
    ds_write_b64 v170, v[92:93] offset:2368
    ds_write_b64 v170, v[94:95] offset:2400
    ds_read_b128 v[184:187], v173 offset:2304
    ds_read_b128 v[188:191], v173 offset:3456
    s_waitcnt lgkmcnt(7)
    buffer_store_dwordx4 v[176:179], v171, s[56:59], s38 offen sc0 sc1 nt
    s_add_u32 s38, s38, 32768
    s_waitcnt lgkmcnt(6)
    buffer_store_dwordx4 v[180:183], v171, s[56:59], s38 offen sc0 sc1 nt
    s_add_u32 s38, s38, 32768
    v_cvt_pk_bf16_f32 v104, v104, v105
    v_cvt_pk_bf16_f32 v105, v106, v107
    v_cvt_pk_bf16_f32 v106, v108, v109
    v_cvt_pk_bf16_f32 v107, v110, v111
    v_cvt_pk_bf16_f32 v108, v112, v113
    v_cvt_pk_bf16_f32 v109, v114, v115
    v_cvt_pk_bf16_f32 v110, v116, v117
    v_cvt_pk_bf16_f32 v111, v118, v119
    ds_write_b64 v170, v[104:105] offset:4608
    ds_write_b64 v170, v[106:107] offset:4640
    ds_write_b64 v170, v[108:109] offset:4672
    ds_write_b64 v170, v[110:111] offset:4704
    ds_read_b128 v[192:195], v173 offset:4608
    ds_read_b128 v[196:199], v173 offset:5760
    s_waitcnt lgkmcnt(7)
    buffer_store_dwordx4 v[184:187], v171, s[56:59], s38 offen sc0 sc1 nt
    s_add_u32 s38, s38, 32768
    s_waitcnt lgkmcnt(6)
    buffer_store_dwordx4 v[188:191], v171, s[56:59], s38 offen sc0 sc1 nt
    s_add_u32 s38, s38, 32768
    v_cvt_pk_bf16_f32 v120, v120, v121
    v_cvt_pk_bf16_f32 v121, v122, v123
    v_cvt_pk_bf16_f32 v122, v124, v125
    v_cvt_pk_bf16_f32 v123, v126, v127
    v_cvt_pk_bf16_f32 v124, v128, v129
    v_cvt_pk_bf16_f32 v125, v130, v131
    v_cvt_pk_bf16_f32 v126, v132, v133
    v_cvt_pk_bf16_f32 v127, v134, v135
    ds_write_b64 v170, v[120:121] offset:6912
    ds_write_b64 v170, v[122:123] offset:6944
    ds_write_b64 v170, v[124:125] offset:6976
    ds_write_b64 v170, v[126:127] offset:7008
    ds_read_b128 v[200:203], v173 offset:6912
    ds_read_b128 v[204:207], v173 offset:8064
    s_waitcnt lgkmcnt(7)
    buffer_store_dwordx4 v[192:195], v171, s[56:59], s38 offen sc0 sc1 nt
    s_add_u32 s38, s38, 32768
    s_waitcnt lgkmcnt(6)
    buffer_store_dwordx4 v[196:199], v171, s[56:59], s38 offen sc0 sc1 nt
    s_add_u32 s38, s38, 32768
    s_waitcnt lgkmcnt(1)
    buffer_store_dwordx4 v[200:203], v171, s[56:59], s38 offen sc0 sc1 nt
    s_add_u32 s38, s38, 32768
    s_waitcnt lgkmcnt(0)
    buffer_store_dwordx4 v[204:207], v171, s[56:59], s38 offen sc0 sc1 nt
    s_add_u32 s38, s38, 32768
L_fin:
L_end:
    s_endpgm
.section .rodata,"a"
.p2align 6
.amdhsa_kernel concat_heads__linear_kernel_hedgehog__mha_block__prompt_kernel
  .amdhsa_next_free_vgpr 256
  .amdhsa_next_free_sgpr 102
  .amdhsa_accum_offset 256
  .amdhsa_group_segment_fixed_size 0
  .amdhsa_kernarg_size 80
  .amdhsa_user_sgpr_count 2
  .amdhsa_user_sgpr_kernarg_segment_ptr 1
  .amdhsa_system_sgpr_workgroup_id_x 1
.end_amdhsa_kernel
```
